```python
import torch

def _softmax(x, axis=-1):
    return torch.softmax(x, dim=axis)

def _gelu(x):
    return torch.nn.functional.gelu(x, approximate='tanh')

def _silu(x):
    return torch.nn.functional.silu(x)

def _sigmoid(x):
    return torch.sigmoid(x)

def _layernorm(x, axis=-1, eps=1e-05):
    m = x.mean(dim=axis, keepdim=True)
    v = x.var(dim=axis, keepdim=True, unbiased=False)
    return (x - m) / torch.sqrt(v + eps)

def _scatter_add(tgt, idx, src, axis=0):
    return tgt.clone().index_add_(axis, idx, src)

def _segment_sum(src, seg, n):
    out = torch.zeros((n,) + src.shape[1:], dtype=src.dtype)
    return out.index_add_(0, seg, src)

def _pad(x, pw):
    flat = tuple((v for pair in reversed(pw) for v in pair))
    return torch.nn.functional.pad(x, flat)
kernel_name = 'adaLN_cond__ssm_conv_s4__glu_gated_glu__prompt'

def setup_inputs():

    _w = lambda a: (lambda t: t.to(torch.bfloat16) if t.is_floating_point() else t)(torch.as_tensor(a))

    def _A_setup():
        B, L, D, N = (1, 2048, 512, 128)
        A_re = -(lambda _x: torch.exp(torch.as_tensor(_x)))((lambda *s: torch.randn(*s, dtype=torch.bfloat16) * 3.2)(D, N))
        A_im = torch.pi * (lambda *s: torch.randn(*s, dtype=torch.bfloat16) * 0.1)(D, N)
        B_re = (lambda *s: torch.randn(*s, dtype=torch.bfloat16) * 0.2)(D, N)
        B_im = (lambda *s: torch.randn(*s, dtype=torch.bfloat16) * 0.2)(D, N)
        C_re = (lambda *s: torch.randn(*s, dtype=torch.bfloat16) * 0.2)(D, N)
        C_im = (lambda *s: torch.randn(*s, dtype=torch.bfloat16) * 0.2)(D, N)
        log_dt = (lambda *s: torch.randn(*s, dtype=torch.bfloat16) * 0.1)(D) * 0.5 - 4.0
        Dskip = (lambda *s: torch.randn(*s, dtype=torch.bfloat16) * 0.1)(D)
        return {'u': _w((lambda *s: torch.randn(*s, dtype=torch.bfloat16) * 0.05)(B, L, D)), 'A_re': _w(A_re), 'A_im': _w(A_im), 'B_re': _w(B_re), 'B_im': _w(B_im), 'C_re': _w(C_re), 'C_im': _w(C_im), 'log_dt': _w(log_dt), 'Dskip': _w(Dskip)}
    _A_in = _A_setup()

    def _B_setup():
        B, S, D, F = (1, 2048, 512, 1792)
        return {'x': _w((lambda *s: torch.randn(*s, dtype=torch.bfloat16) * 0.05)(B, S, D)), 'w_gate': _w((lambda *s: torch.randn(*s, dtype=torch.bfloat16) * 0.05)(D, F)), 'w_up': _w((lambda *s: torch.randn(*s, dtype=torch.bfloat16) * 0.05)(D, F)), 'w_down': _w((lambda *s: torch.randn(*s, dtype=torch.bfloat16) * 0.05)(F, D))}
    _B_in = _B_setup()
    return {'A_u': _A_in['u'], 'A_A_re': _A_in['A_re'], 'A_A_im': _A_in['A_im'], 'A_B_re': _A_in['B_re'], 'A_B_im': _A_in['B_im'], 'A_C_re': _A_in['C_re'], 'A_C_im': _A_in['C_im'], 'A_log_dt': _A_in['log_dt'], 'A_Dskip': _A_in['Dskip'], 'B_x': _B_in['x'], 'B_w_gate': _B_in['w_gate'], 'B_w_up': _B_in['w_up'], 'B_w_down': _B_in['w_down'], 'c': _w((lambda *s: torch.randn(*s, dtype=torch.bfloat16) * 0.1)(1, 512) * 8.0), 'w_mod': _w((lambda *s: torch.randn(*s, dtype=torch.bfloat16) * 0.1)(512, 6 * 512) * 512 ** (-0.5) * 8.0)}

def reference(A_u, A_A_re, A_A_im, A_B_re, A_B_im, A_C_re, A_C_im, A_log_dt, A_Dskip, B_x, B_w_gate, B_w_up, B_w_down, c, w_mod):

    def _A_ref(u, A_re, A_im, B_re, B_im, C_re, C_im, log_dt, Dskip):
        Bsz, L, D = u.shape
        dt = torch.exp(log_dt)[:, None]
        A = A_re + 1j * A_im
        Bc = B_re + 1j * B_im
        Cc = C_re + 1j * C_im
        logdA = dt * A
        dB = dt * Bc
        l = (lambda x, dt: x.to(dt))(torch.arange(L), A_re.dtype)
        P = torch.exp(logdA[:, :, None] * l[None, None, :])
        K = torch.einsum('dn,dnl,dn->dl', Cc, P, dB).real
        L2 = 2 * L
        Kp = _pad(K, ((0, 0), (0, L)))
        up = (lambda x, *d: x.permute(*d))(u, 0, 2, 1)
        up = _pad(up, ((0, 0), (0, 0), (0, L)))
        Kf = (lambda x, axes=(-2, -1): torch.fft.rfft2(x.float(), dim=axes))(Kp[:, None, :], axes=(-2, -1))
        Uf = (lambda x, axes=(-2, -1): torch.fft.rfft2(x.float(), dim=axes))(up[:, :, None, :], axes=(-2, -1))
        Yf = Uf * Kf[None, :, :, :]
        y = (lambda x, s, axes=(-2, -1): torch.fft.irfft2(x, s=s, dim=axes).to(torch.bfloat16))(Yf, (1, L2), axes=(-2, -1))[:, :, 0, :L]
        y = (lambda x, *d: x.permute(*d))(y, 0, 2, 1) + u * Dskip[None, None, :]
        return y

    def _B_ref(x, w_gate, w_up, w_down):
        g = torch.einsum('bsd,df->bsf', x, w_gate)
        u = torch.einsum('bsd,df->bsf', x, w_up)
        h = _sigmoid(g) * u
        return torch.einsum('bsf,fd->bsd', h, w_down)
    x = A_u
    mod = (_silu(c) @ w_mod).reshape(c.shape[0], 6, 1, -1)
    sa, ca, ga, sb, cb, gb = (mod[:, 0].clone(), mod[:, 1].clone(), mod[:, 2].clone(), mod[:, 3].clone(), mod[:, 4].clone(), mod[:, 5].clone())
    h = _layernorm(x, axis=-1) * (1 + ca) + sa
    x = x + ga * _A_ref(h, A_A_re, A_A_im, A_B_re, A_B_im, A_C_re, A_C_im, A_log_dt, A_Dskip)
    h = _layernorm(x, axis=-1) * (1 + cb) + sb
    x = x + gb * _B_ref(h, B_w_gate, B_w_up, B_w_down)
    return x
```

```asm
; @launch grid=(256,1,1) block=(256,1,1) lds=160256
.amdgcn_target "amdgcn-amd-amdhsa--gfx950"
.text
.globl adaLN_cond__ssm_conv_s4__glu_gated_glu__prompt_kernel
.p2align 8
.type adaLN_cond__ssm_conv_s4__glu_gated_glu__prompt_kernel,@function
adaLN_cond__ssm_conv_s4__glu_gated_glu__prompt_kernel:
    s_cmp_ge_u32 s2, 256
    s_cbranch_scc1 L_end
    s_load_dwordx16 s[16:31], s[0:1], 0
    s_load_dwordx16 s[32:47], s[0:1], 64
    s_load_dwordx4 s[48:51], s[0:1], 128
    s_lshr_b32 s5, s2, 3
    s_getpc_b64 s[8:9]
    s_mul_i32 s4, s5, ((L_code_end - adaLN_cond__ssm_conv_s4__glu_gated_glu__prompt_kernel + 31*128) / 4096 * 128)
    v_lshl_add_u32 v4, v0, 3, s4
    v_min_u32 v4, (L_code_end - adaLN_cond__ssm_conv_s4__glu_gated_glu__prompt_kernel - 128), v4
    v_mov_b32 v5, 0
    v_lshl_add_u64 v[4:5], v[4:5], 0, s[8:9]
    global_load_dword v6, v[4:5], off
    v_and_b32 v1, 63, v0
    v_lshrrev_b32_e64 v2, 6, v0
    s_nop 0
    v_readfirstlane_b32 s3, v2
    s_and_b32 s4, s2, 7
    s_lshl_b32 s75, s4, 5
    s_add_u32 s75, s75, s5
    s_mov_b32 s12, 131072
    s_waitcnt lgkmcnt(0)
    s_load_dword s72, s[50:51], 0
    s_mov_b32 s56, s16
    s_and_b32 s57, s17, 0xffff
    s_mov_b32 s58, 0x200000
    s_mov_b32 s59, 0x20000
    v_and_b32 v60, 3, v1
    v_lshlrev_b32 v60, 11, v60
    v_and_b32 v61, 60, v1
    v_add_u32_e64 v60, v60, v61
    s_lshl_b32 s4, s2, 13
    s_lshl_b32 s5, s3, 8
    s_add_u32 s4, s4, s5
    buffer_load_dword v16, v60, s[56:59], s4 offen offset:0 nt
    buffer_load_dword v18, v60, s[56:59], s4 offen offset:1024 nt
    buffer_load_dword v20, v60, s[56:59], s4 offen offset:64 nt
    buffer_load_dword v22, v60, s[56:59], s4 offen offset:1088 nt
    buffer_load_dword v24, v60, s[56:59], s4 offen offset:128 nt
    buffer_load_dword v26, v60, s[56:59], s4 offen offset:1152 nt
    buffer_load_dword v28, v60, s[56:59], s4 offen offset:192 nt
    buffer_load_dword v30, v60, s[56:59], s4 offen offset:1216 nt
    v_mov_b32 v8, 0
    v_mov_b32 v9, 0
    v_mov_b32 v10, 0
    v_mov_b32 v11, 0
    v_mov_b32 v12, 0
    v_mov_b32 v13, 0
    v_mov_b32 v14, 0
    s_lshl_b32 s4, s75, 9
    v_lshl_add_u32 v62, v0, 1, s4
    global_load_short_d16_hi v8, v62, s[18:19] nt
    global_load_short_d16_hi v9, v62, s[20:21] nt
    global_load_short_d16_hi v10, v62, s[22:23] nt
    global_load_short_d16_hi v11, v62, s[24:25] nt
    global_load_short_d16_hi v12, v62, s[26:27] nt
    global_load_short_d16_hi v13, v62, s[28:29] nt
    s_lshl_b32 s4, s75, 2
    v_lshrrev_b32 v63, 7, v0
    v_lshl_add_u32 v63, v63, 1, s4
    global_load_short_d16_hi v14, v63, s[30:31]
    v_mov_b32_e64 v63, s4
    global_load_dword v48, v63, s[32:33]
    s_mov_b32 s60, s44
    s_and_b32 s61, s45, 0xffff
    s_mov_b32 s62, 0x300000
    s_mov_b32 s63, 0x20000
    s_cmp_ge_u32 s2, 192
    s_cbranch_scc1 L_j2i_done
    s_mul_hi_u32 s8, s2, 0x5555556
    s_mul_i32 s9, s8, 48
    s_sub_u32 s9, s2, s9
    v_lshrrev_b32 v60, 3, v0
    s_lshl_b32 s4, s8, 8
    v_lshl_add_u32 v61, v60, 1, s4
    v_mul_u32_u24 v60, 6144, v60
    v_and_b32_e64 v62, 7, v0
    v_lshl_add_u32 v60, v62, 4, v60
    s_mul_i32 s4, s8, 786432
    s_lshl_b32 s5, s9, 7
    s_add_u32 s4, s4, s5
    buffer_load_dwordx4 v[128:131], v60, s[60:63], s4 offen nt
    s_add_u32 s4, s4, 196608
    buffer_load_dwordx4 v[132:135], v60, s[60:63], s4 offen nt
    s_add_u32 s4, s4, 196608
    buffer_load_dwordx4 v[136:139], v60, s[60:63], s4 offen nt
    s_add_u32 s4, s4, 196608
    buffer_load_dwordx4 v[140:143], v60, s[60:63], s4 offen nt
    v_mov_b32 v144, 0
    v_mov_b32 v145, 0
    v_mov_b32 v146, 0
    v_mov_b32 v147, 0
    global_load_short_d16_hi v144, v61, s[42:43] offset:0
    global_load_short_d16_hi v145, v61, s[42:43] offset:64
    global_load_short_d16_hi v146, v61, s[42:43] offset:128
    global_load_short_d16_hi v147, v61, s[42:43] offset:192
    s_mul_i32 s10, s8, 27008
    s_lshr_b32 s5, s9, 3
    s_mul_i32 s5, s5, 384
    s_add_u32 s10, s10, s5
    s_lshl_b32 s5, s9, 9
    s_add_u32 s10, s10, s5
    s_add_u32 s10, s10, 0x20000
L_j2i_done:
    s_mov_b32 s52, s50
    s_and_b32 s53, s51, 0xffff
    s_mov_b32 s54, 0x1880000
    s_mov_b32 s55, 0x20000
    s_mov_b32 s64, s46
    s_and_b32 s65, s47, 0xffff
    s_mov_b32 s66, 0x200000
    s_mov_b32 s67, 0x20000
    s_mov_b32 s68, s40
    s_and_b32 s69, s41, 0xffff
    s_mov_b32 s70, 0x1c0000
    s_mov_b32 s71, 0x20000
    v_mov_b32 v192, 0
    v_mov_b32 v193, 0
    v_mov_b32 v194, 0
    v_mov_b32 v195, 0
    v_lshlrev_b32 v251, 4, v1
    v_lshlrev_b32_e64 v252, 4, v0
    s_mov_b64 exec, 0x3fffffff
    ds_write_b128 v251, v[192:195] offset:20864
    ds_write_b128 v251, v[192:195] offset:25472
    s_mov_b64 exec, 3
    s_nop 0
    ds_write_b128 v251, v[192:195] offset:8320
    ds_write_b128 v251, v[192:195] offset:12480
    ds_write_b128 v251, v[192:195] offset:2048
    ds_write_b128 v251, v[192:195] offset:16640
    ds_write_b128 v251, v[192:195] offset:20800
    ds_write_b128 v251, v[192:195] offset:4160
    s_mov_b64 exec, -1
    v_and_b32 v192, 15, v1
    v_lshrrev_b32 v193, 4, v1
    v_and_b32 v195, 3, v1
    v_lshrrev_b32_e64 v196, 2, v1
    v_mul_u32_u24 v196, 16640, v196
    v_lshl_add_u32 v59, v195, 4, v196
    v_lshlrev_b32 v195, 3, v195
    v_and_b32 v196, 1, v193
    v_lshl_add_u32 v195, v196, 2, v195
    v_and_b32 v196, 32, v1
    s_lshl_b32 s4, s3, 6
    s_add_u32 s4, s4, 158720
    v_add3_u32 v72, v195, v196, s4
    v_and_b32 v195, 7, v1
    v_lshlrev_b32 v73, 2, v195
    v_add_u32 v73, 158720, v73
    v_lshlrev_b32_e64 v195, 5, v195
    v_lshl_add_u32 v195, v193, 3, v195
    s_lshl_b32 s4, s3, 8
    s_add_u32 s4, s4, 158976
    v_add_u32 v75, s4, v195
    v_lshlrev_b32_e64 v76, 2, v1
    v_add_u32 v76, 158976, v76
    v_lshrrev_b32 v195, 3, v1
    v_min_u32 v195, 5, v195
    v_mul_u32_u24 v5, 4480, v195
    v_and_b32_e64 v196, 3, v1
    v_mul_u32_u24 v196, 27008, v196
    v_and_b32_e64 v197, 4, v1
    v_lshl_add_u32 v196, v197, 1, v196
    v_add_u32 v5, v5, v196
    v_cmp_eq_u32 vcc, 1, v195
    v_cmp_eq_u32 s[6:7], 4, v195
    s_nop 0
    s_or_b64 vcc, vcc, s[6:7]
    v_subrev_u32 v7, 3, v195
    v_lshlrev_b32 v7, 11, v7
    v_cndmask_b32 v4, 0, 1.0, vcc
    v_lshlrev_b32_e64 v196, 3, v0
    v_sub_u32 v196, 2047, v196
    v_cvt_f32_i32 v198, v196
    v_add_f32 v199, 0xbf800000, v198
    v_add_f32_e64 v200, 0xc0000000, v198
    v_add_f32 v201, 0xc0400000, v198
    v_add_f32_e64 v202, 0xc0800000, v198
    v_add_f32 v203, 0xc0a00000, v198
    v_add_f32 v204, 0xc0c00000, v198
    v_add_f32 v205, 0xc0e00000, v198
    v_add_f32 v206, 0xc1000000, v198
    v_add_f32 v207, 0xc1100000, v198
    v_cvt_pk_bf16_f32 v208, v198, v199
    v_cvt_pk_bf16_f32 v209, v200, v201
    v_cvt_pk_bf16_f32 v210, v202, v203
    v_cvt_pk_bf16_f32 v211, v204, v205
    v_cvt_pk_bf16_f32 v212, v206, v207
    s_movk_i32 s4, 0x4300
    s_mov_b32 s5, 0xffff7b00
    v_and_b32 v50, 0xffff, v208
    v_add_u32 v214, 0x4280, v196
    v_med3_i32 v50, v50, v214, s4
    v_lshl_add_u32 v50, v50, 1, s5
    v_lshrrev_b32 v51, 16, v208
    v_add_u32 v215, 0x427f, v196
    v_med3_i32 v51, v51, v215, s4
    v_lshl_add_u32 v51, v51, 1, s5
    v_and_b32 v52, 0xffff, v209
    v_add_u32 v214, 0x427e, v196
    v_med3_i32 v52, v52, v214, s4
    v_lshl_add_u32 v52, v52, 1, s5
    v_lshrrev_b32_e64 v53, 16, v209
    v_add_u32 v215, 0x427d, v196
    v_med3_i32 v53, v53, v215, s4
    v_lshl_add_u32 v53, v53, 1, s5
    v_and_b32 v54, 0xffff, v210
    v_add_u32 v214, 0x427c, v196
    v_med3_i32 v54, v54, v214, s4
    v_lshl_add_u32 v54, v54, 1, s5
    v_lshrrev_b32_e64 v55, 16, v210
    v_add_u32 v215, 0x427b, v196
    v_med3_i32 v55, v55, v215, s4
    v_lshl_add_u32 v55, v55, 1, s5
    v_and_b32 v56, 0xffff, v211
    v_add_u32 v214, 0x427a, v196
    v_med3_i32 v56, v56, v214, s4
    v_lshl_add_u32 v56, v56, 1, s5
    v_lshrrev_b32_e64 v57, 16, v211
    v_add_u32 v215, 0x4279, v196
    v_med3_i32 v57, v57, v215, s4
    v_lshl_add_u32 v57, v57, 1, s5
    v_and_b32 v58, 0xffff, v212
    v_add_u32 v214, 0x4278, v196
    v_med3_i32 v58, v58, v214, s4
    v_lshl_add_u32 v58, v58, 1, s5
    v_mov_b32 v214, 2048
    v_cmp_eq_u32 vcc, 0xff, v0
    v_lshrrev_b32_e64 v236, 7, v0
    v_mul_u32_u24 v236, 28832, v236
    v_cndmask_b32 v58, v58, v214, vcc
    v_and_b32 v195, 127, v0
    v_lshl_add_u32 v236, v195, 2, v236
    v_add_u32 v236, 40960, v236
    v_mul_u32_u24 v237, 544, v192
    v_lshl_add_u32 v237, v193, 4, v237
    s_lshr_b32 s14, s3, 1
    s_and_b32 s15, s3, 1
    s_mul_i32 s4, s14, 28832
    s_add_u32 s4, s4, 40960
    v_add_u32 v237, s4, v237
    s_mul_i32 s5, s15, 8704
    v_add_u32 v238, s5, v237
    s_lshl_b32 s5, s15, 4
    v_add_u32_e64 v194, s5, v192
    s_mul_i32 s4, s14, 2112
    v_lshlrev_b32 v239, 4, v194
    v_add_u32 v195, 8, v239
    v_cmp_eq_u32 vcc, 1, v193
    v_lshlrev_b32 v196, 3, v194
    v_add_u32 v196, 512, v196
    v_cndmask_b32 v239, v239, v195, vcc
    v_cmp_eq_u32 vcc, 2, v193
    v_lshlrev_b32_e64 v195, 2, v194
    v_add_u32 v195, 768, v195
    v_cndmask_b32 v239, v239, v196, vcc
    v_cmp_eq_u32 vcc, 3, v193
    v_mov_b32_e64 v196, 4
    v_mov_b32 v197, 128
    v_cndmask_b32 v239, v239, v195, vcc
    v_cndmask_b32 v196, v196, v197, vcc
    v_add_u32 v239, s4, v239
    v_add_u32 v240, v239, v196
    v_lshlrev_b32_e64 v241, 8, v193
    v_lshl_add_u32 v241, v194, 1, v241
    v_add_u32 v241, s4, v241
    v_lshlrev_b32 v195, 3, v193
    v_sub_u32_e64 v195, v195, v192
    v_add_u32 v195, 2031, v195
    v_and_b32_e64 v196, 1, v195
    v_mul_u32_u24 v196, 4160, v196
    v_lshrrev_b32_e64 v195, 1, v195
    v_lshl_add_u32 v195, v195, 2, v196
    s_mul_i32 s5, s14, 8320
    s_lshl_b32 s6, s15, 6
    s_sub_u32 s5, s5, s6
    s_add_u32 s5, s5, 3328
    v_add_u32_e64 v242, s5, v195
    s_sub_u32 s5, s5, 1024
    v_add_u32_e64 v243, s5, v195
    s_sub_u32 s5, s5, 1024
    v_add_u32_e64 v244, s5, v195
    s_sub_u32 s5, s5, 1024
    v_add_u32_e64 v245, s5, v195
    s_mul_i32 s5, s14, 4608
    s_sub_u32 s5, s5, s6
    s_add_u32 s5, s5, 20928
    v_lshlrev_b32 v246, 5, v192
    v_lshl_add_u32 v246, v193, 4, v246
    v_add_u32_e64 v246, s5, v246
    v_mul_u32_u24 v195, 320, v193
    v_lshl_add_u32 v247, v192, 4, v195
    s_mul_i32 s4, s3, 5120
    v_add_u32 v247, s4, v247
    v_and_b32 v195, 3, v1
    v_mul_u32_u24 v195, 320, v195
    v_lshrrev_b32_e64 v196, 2, v1
    v_lshl_add_u32 v248, v196, 4, v195
    s_mul_i32 s4, s3, 1280
    v_add_u32 v248, s4, v248
    s_lshl_b32 s4, s3, 9
    v_lshl_add_u32 v249, v1, 3, s4
    v_lshlrev_b32_e64 v250, 1, v249
    v_lshl_add_u32 v253, v1, 2, s4
    v_lshlrev_b32 v255, 7, v1
    v_and_b32 v64, 15, v1
    v_lshrrev_b32 v65, 4, v1
    v_lshrrev_b32 v66, 2, v64
    v_and_b32_e64 v67, 1, v64
    v_lshl_add_u32 v66, v66, 1, v67
    v_lshlrev_b32_e64 v66, 4, v66
    v_mul_u32_u24 v67, 28672, v65
    s_lshl_b32 s4, s2, 2
    s_add_u32 s4, s4, s3
    s_sub_u32 s5, s4, 896
    s_cmp_ge_u32 s4, 896
    s_cselect_b32 s13, s5, s4
    s_lshr_b32 s4, s13, 5
    s_bfe_u32 s5, s13, 0x40001
    s_and_b32 s6, s13, 1
    s_lshl_b32 s73, s4, 3
    s_lshl_b32 s7, s6, 2
    s_add_u32 s73, s73, s7
    s_lshl_b32 s73, s73, 4
    s_add_u32 s73, s73, s5
    s_lshl_b32 s73, s73, 10
    s_add_u32 s73, s73, 0x1500000
    s_cmp_ge_u32 s2, 224
    s_cselect_b32 s73, 0x40000000, s73
    s_lshl_b32 s4, s4, 7
    s_mul_i32 s5, s5, 114688
    s_lshl_b32 s6, s6, 3
    s_add_u32 s4, s4, s5
    s_add_u32 s4, s4, s6
    s_add_u32 s4, s4, 3584
    v_add3_u32 v66, v66, v67, s4
    v_and_b32 v67, 2, v64
    v_cmp_eq_u32 vcc, 0, v67
    v_mov_b32 v94, s38
    v_mov_b32 v95, s39
    v_mov_b32 v67, s36
    v_mov_b32 v68, s37
    v_cndmask_b32 v94, v94, v67, vcc
    v_cndmask_b32 v95, v95, v68, vcc
    v_add_co_u32 v94, vcc, v94, v66
    s_nop 1
    v_addc_co_u32 v95, vcc, 0, v95, vcc
    s_lshl_b32 s4, s2, 1
    s_add_u32 s4, s4, s3
    s_lshr_b32 s7, s4, 3
    s_bfe_u32 s6, s4, 0x20001
    s_and_b32 s5, s4, 1
    s_lshr_b32 s11, s7, 1
    s_lshl_b32 s11, s11, 16
    s_and_b32 s4, s7, 1
    s_lshl_b32 s4, s4, 12
    s_add_u32 s11, s11, s4
    s_lshl_b32 s4, s6, 10
    s_add_u32 s11, s11, s4
    s_lshl_b32 s4, s5, 9
    s_add_u32 s11, s11, s4
    s_mul_i32 s5, s5, 917504
    s_lshl_b32 s7, s7, 10
    s_lshl_b32 s6, s6, 8
    s_add_u32 s5, s5, s7
    s_add_u32 s5, s5, s6
    s_add_u32 s13, s5, 0x100000
    s_cmp_ge_u32 s2, 224
    s_cselect_b32 s4, 2, s3
    s_cmp_ge_u32 s4, 2
    s_cselect_b32 s13, 0x40000000, s13
    s_cselect_b32 s11, 0x40000000, s11
    v_lshlrev_b32 v232, 3, v1
    v_lshrrev_b32 v224, 4, v1
    v_mul_u32_u24 v224, 229376, v224
    v_and_b32_e64 v64, 15, v1
    v_lshl_add_u32 v224, v64, 4, v224
    s_and_b32 s4, s2, 7
    s_lshr_b32 s5, s2, 3
    s_and_b32 s76, s4, 0
    s_lshr_b32 s6, s5, 2
    s_add_u32 s76, s76, s6
    s_and_b32 s77, s4, 7
    s_lshl_b32 s77, s77, 2
    s_and_b32 s7, s5, 3
    s_add_u32 s77, s77, s7
    s_lshl_b32 s6, s76, 9
    s_lshl_b32 s7, s3, 7
    s_add_u32 s79, s6, s7
    s_lshr_b32 s89, s4, 0
    s_lshl_b32 s89, s89, 2
    s_lshr_b32 s6, s5, 3
    s_add_u32 s89, s89, s6
    s_and_b32 s90, s4, 0
    s_lshl_b32 s90, s90, 3
    s_and_b32 s6, s5, 7
    s_add_u32 s90, s90, s6
    s_lshl_b32 s88, s2, 7
    s_lshl_b32 s5, s3, 2
    s_add_u32 s88, s88, s5
    s_add_u32 s88, s88, 0x10000
    s_mov_b32 s36, 0x18000
    s_mov_b32 s37, 0x1a000
    s_mul_i32 s38, s2, 4
    s_add_u32 s39, s38, 0x1a000
    s_add_u32 s38, s38, 0x18000
    s_waitcnt lgkmcnt(0)
    s_add_u32 s72, s72, 1
    v_mov_b32 v17, s72
    v_mov_b32 v19, s72
    v_mov_b32 v21, s72
    v_mov_b32 v23, s72
    v_mov_b32 v25, s72
    v_mov_b32 v27, s72
    v_mov_b32 v29, s72
    v_mov_b32 v31, s72
    s_cmp_ge_u32 s2, 192
    s_cbranch_scc1 L_pw
    s_waitcnt vmcnt(8)
    s_branch L_pw2
L_pw:
    s_waitcnt vmcnt(0)
L_pw2:
    s_cmp_ge_u32 s2, 128
    s_cbranch_scc1 L_xt0
    s_lshl_b32 s4, s3, 12
    s_mul_i32 s5, s2, 16640
    s_add_u32 s4, s4, s5
    s_add_u32 s4, s4, 0x800000
    buffer_store_dwordx4 v[16:19], v251, s[52:55], s4 offen offset:0 sc1
    buffer_store_dwordx4 v[20:23], v251, s[52:55], s4 offen offset:1024 sc1
    buffer_store_dwordx4 v[24:27], v251, s[52:55], s4 offen offset:2048 sc1
    buffer_store_dwordx4 v[28:31], v251, s[52:55], s4 offen offset:3072 sc1
L_xt0:
    s_nop 1
    s_mov_b32 s6, 0x3f803f80
    v_dot2_f32_bf16 v64, v16, s6, 0
    v_dot2_f32_bf16 v65, v16, v16, 0
    v_dot2_f32_bf16 v66, v18, s6, 0
    v_dot2_f32_bf16 v67, v18, v18, 0
    v_dot2_f32_bf16 v64, v20, s6, v64
    v_dot2_f32_bf16 v65, v20, v20, v65
    v_dot2_f32_bf16 v66, v22, s6, v66
    v_dot2_f32_bf16 v67, v22, v22, v67
    v_dot2_f32_bf16 v64, v24, s6, v64
    v_dot2_f32_bf16 v65, v24, v24, v65
    v_dot2_f32_bf16 v66, v26, s6, v66
    v_dot2_f32_bf16 v67, v26, v26, v67
    v_dot2_f32_bf16 v64, v28, s6, v64
    v_dot2_f32_bf16 v65, v28, v28, v65
    v_dot2_f32_bf16 v66, v30, s6, v66
    v_dot2_f32_bf16 v67, v30, v30, v67
    s_nop 0
    v_permlane32_swap_b32 v64, v65
    s_nop 0
    v_permlane32_swap_b32 v66, v67
    v_add_f32 v64, v64, v65
    v_add_f32 v66, v66, v67
    s_nop 1
    v_permlane16_swap_b32 v64, v66
    v_add_f32 v64, v64, v66
    s_nop 1
    v_add_f32_dpp v64, v64, v64 row_ror:8 row_mask:0xf bank_mask:0xf
    s_nop 1
    v_add_f32_dpp v64, v64, v64 row_ror:4 row_mask:0xf bank_mask:0xf
    ds_write_b32 v72, v64
    s_cmp_ge_u32 s2, 192
    s_cbranch_scc1 L_j2p_done
    s_cmp_ge_u32 s2, 128
    s_cbranch_scc1 L_j2w
    s_waitcnt vmcnt(4)
    s_branch L_j2w2
L_j2w:
    s_waitcnt vmcnt(0)
L_j2w2:
    v_mul_f32 v156, 0xbfb8aa3b, v144
    v_mul_f32 v157, 0xbfb8aa3b, v145
    v_mul_f32 v158, 0xbfb8aa3b, v146
    v_mul_f32 v159, 0xbfb8aa3b, v147
    v_exp_f32 v156, v156
    v_exp_f32 v157, v157
    v_exp_f32 v158, v158
    v_exp_f32 v159, v159
    v_add_f32 v156, 1.0, v156
    v_add_f32 v157, 1.0, v157
    v_add_f32 v158, 1.0, v158
    v_add_f32 v159, 1.0, v159
    v_rcp_f32 v156, v156
    v_rcp_f32 v157, v157
    v_rcp_f32 v158, v158
    v_rcp_f32 v159, v159
    v_lshlrev_b32_e64 v160, 16, v128
    v_and_b32 v161, 0xffff0000, v128
    v_lshlrev_b32_e64 v162, 16, v129
    v_and_b32 v163, 0xffff0000, v129
    v_lshlrev_b32_e64 v164, 16, v130
    v_and_b32 v165, 0xffff0000, v130
    v_lshlrev_b32_e64 v166, 16, v131
    v_and_b32 v167, 0xffff0000, v131
    v_mul_f32 v144, v144, v156
    v_mul_f32 v145, v145, v157
    v_mul_f32 v146, v146, v158
    v_mul_f32 v147, v147, v159
    v_lshlrev_b32_e64 v168, 16, v132
    v_and_b32 v169, 0xffff0000, v132
    v_lshlrev_b32_e64 v170, 16, v133
    v_and_b32 v171, 0xffff0000, v133
    v_lshlrev_b32_e64 v172, 16, v134
    v_and_b32 v173, 0xffff0000, v134
    v_lshlrev_b32_e64 v174, 16, v135
    v_and_b32 v175, 0xffff0000, v135
    v_cvt_pk_bf16_f32 v156, v144, v145
    v_cvt_pk_bf16_f32 v158, v146, v147
    v_lshlrev_b32_e64 v176, 16, v136
    v_and_b32 v177, 0xffff0000, v136
    v_lshlrev_b32_e64 v178, 16, v137
    v_and_b32 v179, 0xffff0000, v137
    v_lshlrev_b32_e64 v180, 16, v138
    v_and_b32 v181, 0xffff0000, v138
    v_lshlrev_b32_e64 v182, 16, v139
    v_and_b32 v183, 0xffff0000, v139
    v_lshlrev_b32_e64 v144, 16, v156
    v_and_b32 v145, 0xffff0000, v156
    v_lshlrev_b32_e64 v146, 16, v158
    v_and_b32 v147, 0xffff0000, v158
    v_lshlrev_b32_e64 v184, 16, v140
    v_and_b32 v185, 0xffff0000, v140
    v_lshlrev_b32_e64 v186, 16, v141
    v_and_b32 v187, 0xffff0000, v141
    v_lshlrev_b32_e64 v188, 16, v142
    v_and_b32 v189, 0xffff0000, v142
    v_lshlrev_b32_e64 v190, 16, v143
    v_and_b32 v191, 0xffff0000, v143
    v_pk_mul_f32 v[148:149], v[160:161], v[144:145] op_sel:[0,0] op_sel_hi:[1,0]
    v_pk_mul_f32 v[150:151], v[162:163], v[144:145] op_sel:[0,0] op_sel_hi:[1,0]
    v_pk_mul_f32 v[152:153], v[164:165], v[144:145] op_sel:[0,0] op_sel_hi:[1,0]
    v_pk_mul_f32 v[154:155], v[166:167], v[144:145] op_sel:[0,0] op_sel_hi:[1,0]
    v_pk_fma_f32 v[148:149], v[168:169], v[144:145], v[148:149] op_sel:[0,1,0] op_sel_hi:[1,1,1]
    v_pk_fma_f32 v[150:151], v[170:171], v[144:145], v[150:151] op_sel:[0,1,0] op_sel_hi:[1,1,1]
    v_pk_fma_f32 v[152:153], v[172:173], v[144:145], v[152:153] op_sel:[0,1,0] op_sel_hi:[1,1,1]
    v_pk_fma_f32 v[154:155], v[174:175], v[144:145], v[154:155] op_sel:[0,1,0] op_sel_hi:[1,1,1]
    v_pk_fma_f32 v[148:149], v[176:177], v[146:147], v[148:149] op_sel:[0,0,0] op_sel_hi:[1,0,1]
    v_pk_fma_f32 v[150:151], v[178:179], v[146:147], v[150:151] op_sel:[0,0,0] op_sel_hi:[1,0,1]
    v_pk_fma_f32 v[152:153], v[180:181], v[146:147], v[152:153] op_sel:[0,0,0] op_sel_hi:[1,0,1]
    v_pk_fma_f32 v[154:155], v[182:183], v[146:147], v[154:155] op_sel:[0,0,0] op_sel_hi:[1,0,1]
    v_pk_fma_f32 v[148:149], v[184:185], v[146:147], v[148:149] op_sel:[0,1,0] op_sel_hi:[1,1,1]
    v_pk_fma_f32 v[150:151], v[186:187], v[146:147], v[150:151] op_sel:[0,1,0] op_sel_hi:[1,1,1]
    v_pk_fma_f32 v[152:153], v[188:189], v[146:147], v[152:153] op_sel:[0,1,0] op_sel_hi:[1,1,1]
    v_pk_fma_f32 v[154:155], v[190:191], v[146:147], v[154:155] op_sel:[0,1,0] op_sel_hi:[1,1,1]
    s_nop 0
    v_permlane32_swap_b32 v148, v152
    v_permlane32_swap_b32 v149, v153
    v_permlane32_swap_b32 v150, v154
    v_permlane32_swap_b32 v151, v155
    v_add_f32 v148, v148, v152
    v_add_f32 v149, v149, v153
    v_add_f32 v150, v150, v154
    v_add_f32 v151, v151, v155
    s_nop 0
    v_permlane16_swap_b32 v148, v150
    v_permlane16_swap_b32 v149, v151
    v_add_f32 v148, v148, v150
    v_add_f32_e64 v149, v149, v151
    s_nop 0
    v_add_f32_dpp v148, v148, v148 row_ror:8 row_mask:0xf bank_mask:0xf
    v_add_f32_dpp v149, v149, v149 row_ror:8 row_mask:0xf bank_mask:0xf
    ds_write_b64 v75, v[148:149]
L_j2p_done:
    s_waitcnt lgkmcnt(0)
    s_barrier
    s_cmp_lg_u32 s3, 0
    s_cbranch_scc1 L_j1f_done
    ds_read2_b32 v[64:65], v73 offset0:0 offset1:8
    ds_read2_b32 v[66:67], v73 offset0:16 offset1:24
    ds_read2_b32 v[68:69], v73 offset0:32 offset1:40
    ds_read2_b32 v[70:71], v73 offset0:48 offset1:56
    s_lshl_b32 s4, s2, 6
    s_add_u32 s4, s4, 0x1000
    v_lshlrev_b32_e64 v60, 3, v1
    s_waitcnt lgkmcnt(0)
    v_pk_add_f32 v[64:65], v[64:65], v[66:67]
    v_pk_add_f32 v[68:69], v[68:69], v[70:71]
    v_pk_add_f32 v[64:65], v[64:65], v[68:69]
    v_mul_f32 v64, 0x3b000000, v64
    v_mul_f32 v65, 0x3b000000, v65
    v_fma_f32 v65, -v64, v64, v65
    v_max_f32_e64 v65, 0, v65
    v_cvt_pk_bf16_f32 v66, v65, v65
    v_lshlrev_b32_e64 v66, 16, v66
    v_add_f32 v66, 0x3727c5ac, v66
    v_cvt_pk_bf16_f32 v66, v66, v66
    v_lshlrev_b32 v66, 16, v66
    v_sqrt_f32_e64 v66, v66
    s_nop 0
    v_cvt_pk_bf16_f32 v66, v66, v64
    v_mov_b32_e64 v67, s72
    s_mov_b64 exec, 0xff
    buffer_store_dwordx2 v[66:67], v60, s[52:55], s4 offen sc1
    s_mov_b64 exec, -1
L_j1f_done:
    s_cmp_lg_u32 s3, 1
    s_cbranch_scc1 L_j2f_done
    s_cmp_ge_u32 s2, 192
    s_cbranch_scc1 L_j2f_done
    ds_read2st64_b32 v[64:65], v76 offset0:0 offset1:1
    ds_read2st64_b32 v[66:67], v76 offset0:2 offset1:3
    v_lshlrev_b32 v60, 3, v1
    s_waitcnt lgkmcnt(0)
    v_pk_add_f32 v[64:65], v[64:65], v[66:67]
    v_add_f32 v64, v64, v65
    v_mov_b32 v65, s72
    buffer_store_dwordx2 v[64:65], v60, s[52:55], s10 offen sc1
L_j2f_done:
    s_nop 1
    s_mov_b32 s4, 10752
    s_mov_b32 s5, 0
    global_load_dwordx2 v[96:97], v[94:95], off offset:-3584
    global_load_dwordx2 v[98:99], v[94:95], off offset:0
    global_load_dwordx2 v[100:101], v[94:95], off offset:3584
    v_lshl_add_u64 v[94:95], v[94:95], 0, s[4:5]
    global_load_dwordx2 v[102:103], v[94:95], off offset:-3584
    global_load_dwordx2 v[104:105], v[94:95], off offset:0
    global_load_dwordx2 v[106:107], v[94:95], off offset:3584
    v_lshl_add_u64 v[94:95], v[94:95], 0, s[4:5]
    global_load_dwordx2 v[108:109], v[94:95], off offset:-3584
    global_load_dwordx2 v[110:111], v[94:95], off offset:0
    v_mul_f32 v15, 0x3fb8aa3b, v14
    v_exp_f32_e64 v15, v15
    v_pk_mul_f32 v[116:117], v[12:13], v[10:11] op_sel:[0,0] op_sel_hi:[1,0]
    v_cvt_pk_bf16_f32 v15, v15, v15
    v_pk_fma_f32 v[116:117], v[12:13], v[10:11], v[116:117] op_sel:[1,1,0] op_sel_hi:[0,1,1] neg_lo:[1,0,0]
    v_lshlrev_b32 v15, 16, v15
    v_mul_f32 v60, v15, v8
    v_mul_f32_e64 v61, v15, v9
    v_mul_f32 v60, 0x3fb8aa3b, v60
    v_mul_f32_e64 v61, 0.15915494, v61
    v_mul_f32 v76, 0x41000000, v60
    v_mul_f32 v79, 0x41000000, v61
    v_mul_f32 v78, 0x43800000, v60
    v_mul_f32 v81, 0x43800000, v61
    v_fract_f32 v79, v79
    v_exp_f32 v76, v76
    v_fract_f32 v80, v61
    v_exp_f32 v77, v60
    v_fract_f32 v81, v81
    v_exp_f32 v78, v78
    v_cos_f32 v160, v79
    v_sin_f32 v161, v79
    v_cos_f32 v64, v80
    v_sin_f32 v65, v80
    v_cos_f32 v70, v81
    v_sin_f32 v71, v81
    v_pk_mul_f32 v[160:161], v[160:161], v[76:77] op_sel:[0,0] op_sel_hi:[1,0]
    v_pk_mul_f32 v[64:65], v[64:65], v[76:77] op_sel:[0,1] op_sel_hi:[1,1]
    v_pk_mul_f32 v[70:71], v[70:71], v[78:79] op_sel:[0,0] op_sel_hi:[1,0]
    v_mov_b32 v76, 0x3f80
    v_pk_mul_f32 v[162:163], v[160:161], v[160:161] op_sel:[0,0] op_sel_hi:[1,0]
    v_pk_mul_f32 v[66:67], v[64:65], v[64:65] op_sel:[0,0] op_sel_hi:[1,0]
    v_pk_mul_f32 v[72:73], v[70:71], v[70:71] op_sel:[0,0] op_sel_hi:[1,0]
    v_pk_fma_f32 v[162:163], v[160:161], v[160:161], v[162:163] op_sel:[1,1,0] op_sel_hi:[0,1,1] neg_lo:[1,0,0]
    v_pk_fma_f32 v[66:67], v[64:65], v[64:65], v[66:67] op_sel:[1,1,0] op_sel_hi:[0,1,1] neg_lo:[1,0,0]
    v_pk_fma_f32 v[72:73], v[70:71], v[70:71], v[72:73] op_sel:[1,1,0] op_sel_hi:[0,1,1] neg_lo:[1,0,0]
    v_cvt_pk_bf16_f32 v84, v116, v117
    v_cvt_pk_bf16_f32 v85, v160, -v161
    ds_write_b32 v236, v76 offset:11424
    ds_write_b32 v236, v84 offset:0
    ds_write_b32 v236, v85 offset:11968
    v_pk_mul_f32 v[118:119], v[116:117], v[64:65] op_sel:[0,0] op_sel_hi:[1,0]
    v_pk_mul_f32 v[132:133], v[116:117], v[70:71] op_sel:[0,0] op_sel_hi:[1,0]
    v_pk_fma_f32 v[118:119], v[116:117], v[64:65], v[118:119] op_sel:[1,1,0] op_sel_hi:[0,1,1] neg_lo:[1,0,0]
    v_pk_fma_f32 v[132:133], v[116:117], v[70:71], v[132:133] op_sel:[1,1,0] op_sel_hi:[0,1,1] neg_lo:[1,0,0]
    v_cvt_pk_bf16_f32 v86, v162, -v163
    ds_write_b32 v236, v86 offset:12512
    v_pk_mul_f32 v[166:167], v[162:163], v[162:163] op_sel:[0,0] op_sel_hi:[1,0]
    v_pk_mul_f32 v[68:69], v[66:67], v[66:67] op_sel:[0,0] op_sel_hi:[1,0]
    v_pk_mul_f32 v[74:75], v[72:73], v[72:73] op_sel:[0,0] op_sel_hi:[1,0]
    v_pk_fma_f32 v[166:167], v[162:163], v[162:163], v[166:167] op_sel:[1,1,0] op_sel_hi:[0,1,1] neg_lo:[1,0,0]
    v_pk_fma_f32 v[68:69], v[66:67], v[66:67], v[68:69] op_sel:[1,1,0] op_sel_hi:[0,1,1] neg_lo:[1,0,0]
    v_pk_fma_f32 v[74:75], v[72:73], v[72:73], v[74:75] op_sel:[1,1,0] op_sel_hi:[0,1,1] neg_lo:[1,0,0]
    v_cvt_pk_bf16_f32 v87, v118, v119
    v_cvt_pk_bf16_f32 v88, v132, v133
    ds_write_b32 v236, v87 offset:544
    ds_write_b32 v236, v88 offset:4352
    v_pk_mul_f32 v[164:165], v[162:163], v[160:161] op_sel:[0,0] op_sel_hi:[1,0]
    v_pk_mul_f32 v[120:121], v[116:117], v[66:67] op_sel:[0,0] op_sel_hi:[1,0]
    v_pk_mul_f32 v[122:123], v[118:119], v[66:67] op_sel:[0,0] op_sel_hi:[1,0]
    v_pk_fma_f32 v[164:165], v[162:163], v[160:161], v[164:165] op_sel:[1,1,0] op_sel_hi:[0,1,1] neg_lo:[1,0,0]
    v_pk_fma_f32 v[120:121], v[116:117], v[66:67], v[120:121] op_sel:[1,1,0] op_sel_hi:[0,1,1] neg_lo:[1,0,0]
    v_pk_fma_f32 v[122:123], v[118:119], v[66:67], v[122:123] op_sel:[1,1,0] op_sel_hi:[0,1,1] neg_lo:[1,0,0]
    v_cvt_pk_bf16_f32 v89, v166, -v167
    ds_write_b32 v236, v89 offset:13600
    v_pk_mul_f32 v[140:141], v[116:117], v[72:73] op_sel:[0,0] op_sel_hi:[1,0]
    v_pk_mul_f32 v[144:145], v[132:133], v[72:73] op_sel:[0,0] op_sel_hi:[1,0]
    v_pk_fma_f32 v[140:141], v[116:117], v[72:73], v[140:141] op_sel:[1,1,0] op_sel_hi:[0,1,1] neg_lo:[1,0,0]
    v_pk_fma_f32 v[144:145], v[132:133], v[72:73], v[144:145] op_sel:[1,1,0] op_sel_hi:[0,1,1] neg_lo:[1,0,0]
    v_cvt_pk_bf16_f32 v90, v164, -v165
    v_cvt_pk_bf16_f32 v91, v120, v121
    v_cvt_pk_bf16_f32 v84, v122, v123
    ds_write_b32 v236, v90 offset:13056
    ds_write_b32 v236, v91 offset:1088
    ds_write_b32 v236, v84 offset:1632
    v_pk_mul_f32 v[174:175], v[166:167], v[166:167] op_sel:[0,0] op_sel_hi:[1,0]
    v_pk_mul_f32 v[124:125], v[116:117], v[68:69] op_sel:[0,0] op_sel_hi:[1,0]
    v_pk_mul_f32 v[126:127], v[118:119], v[68:69] op_sel:[0,0] op_sel_hi:[1,0]
    v_pk_fma_f32 v[174:175], v[166:167], v[166:167], v[174:175] op_sel:[1,1,0] op_sel_hi:[0,1,1] neg_lo:[1,0,0]
    v_pk_fma_f32 v[124:125], v[116:117], v[68:69], v[124:125] op_sel:[1,1,0] op_sel_hi:[0,1,1] neg_lo:[1,0,0]
    v_pk_fma_f32 v[126:127], v[118:119], v[68:69], v[126:127] op_sel:[1,1,0] op_sel_hi:[0,1,1] neg_lo:[1,0,0]
    v_cvt_pk_bf16_f32 v85, v140, v141
    v_cvt_pk_bf16_f32 v86, v144, v145
    ds_write_b32 v236, v85 offset:6528
    ds_write_b32 v236, v86 offset:7616
    v_pk_mul_f32 v[128:129], v[120:121], v[68:69] op_sel:[0,0] op_sel_hi:[1,0]
    v_pk_mul_f32 v[130:131], v[122:123], v[68:69] op_sel:[0,0] op_sel_hi:[1,0]
    v_pk_mul_f32 v[168:169], v[166:167], v[160:161] op_sel:[0,0] op_sel_hi:[1,0]
    v_pk_fma_f32 v[128:129], v[120:121], v[68:69], v[128:129] op_sel:[1,1,0] op_sel_hi:[0,1,1] neg_lo:[1,0,0]
    v_pk_fma_f32 v[130:131], v[122:123], v[68:69], v[130:131] op_sel:[1,1,0] op_sel_hi:[0,1,1] neg_lo:[1,0,0]
    v_pk_fma_f32 v[168:169], v[166:167], v[160:161], v[168:169] op_sel:[1,1,0] op_sel_hi:[0,1,1] neg_lo:[1,0,0]
    v_cvt_pk_bf16_f32 v87, v174, -v175
    v_cvt_pk_bf16_f32 v88, v124, v125
    v_cvt_pk_bf16_f32 v89, v126, v127
    ds_write_b32 v236, v87 offset:15776
    ds_write_b32 v236, v88 offset:2176
    ds_write_b32 v236, v89 offset:2720
    v_pk_mul_f32 v[170:171], v[166:167], v[162:163] op_sel:[0,0] op_sel_hi:[1,0]
    v_pk_mul_f32 v[172:173], v[166:167], v[164:165] op_sel:[0,0] op_sel_hi:[1,0]
    v_pk_fma_f32 v[170:171], v[166:167], v[162:163], v[170:171] op_sel:[1,1,0] op_sel_hi:[0,1,1] neg_lo:[1,0,0]
    v_pk_fma_f32 v[172:173], v[166:167], v[164:165], v[172:173] op_sel:[1,1,0] op_sel_hi:[0,1,1] neg_lo:[1,0,0]
    v_cvt_pk_bf16_f32 v90, v128, v129
    v_cvt_pk_bf16_f32 v91, v130, v131
    v_cvt_pk_bf16_f32 v84, v168, -v169
    ds_write_b32 v236, v90 offset:3264
    ds_write_b32 v236, v91 offset:3808
    ds_write_b32 v236, v84 offset:14144
    v_pk_mul_f32 v[134:135], v[120:121], v[70:71] op_sel:[0,0] op_sel_hi:[1,0]
    v_pk_mul_f32 v[148:149], v[116:117], v[74:75] op_sel:[0,0] op_sel_hi:[1,0]
    v_pk_mul_f32 v[150:151], v[132:133], v[74:75] op_sel:[0,0] op_sel_hi:[1,0]
    v_pk_fma_f32 v[134:135], v[120:121], v[70:71], v[134:135] op_sel:[1,1,0] op_sel_hi:[0,1,1] neg_lo:[1,0,0]
    v_pk_fma_f32 v[148:149], v[116:117], v[74:75], v[148:149] op_sel:[1,1,0] op_sel_hi:[0,1,1] neg_lo:[1,0,0]
    v_pk_fma_f32 v[150:151], v[132:133], v[74:75], v[150:151] op_sel:[1,1,0] op_sel_hi:[0,1,1] neg_lo:[1,0,0]
    v_cvt_pk_bf16_f32 v85, v170, -v171
    v_cvt_pk_bf16_f32 v86, v172, -v173
    ds_write_b32 v236, v85 offset:14688
    ds_write_b32 v236, v86 offset:15232
    v_pk_mul_f32 v[152:153], v[140:141], v[74:75] op_sel:[0,0] op_sel_hi:[1,0]
    v_pk_mul_f32 v[154:155], v[144:145], v[74:75] op_sel:[0,0] op_sel_hi:[1,0]
    v_pk_mul_f32 v[190:191], v[174:175], v[174:175] op_sel:[0,0] op_sel_hi:[1,0]
    v_pk_fma_f32 v[152:153], v[140:141], v[74:75], v[152:153] op_sel:[1,1,0] op_sel_hi:[0,1,1] neg_lo:[1,0,0]
    v_pk_fma_f32 v[154:155], v[144:145], v[74:75], v[154:155] op_sel:[1,1,0] op_sel_hi:[0,1,1] neg_lo:[1,0,0]
    v_pk_fma_f32 v[190:191], v[174:175], v[174:175], v[190:191] op_sel:[1,1,0] op_sel_hi:[0,1,1] neg_lo:[1,0,0]
    v_cvt_pk_bf16_f32 v87, v134, v135
    v_cvt_pk_bf16_f32 v88, v148, v149
    v_cvt_pk_bf16_f32 v89, v150, v151
    ds_write_b32 v236, v87 offset:4896
    ds_write_b32 v236, v88 offset:8704
    ds_write_b32 v236, v89 offset:9248
    v_pk_mul_f32 v[136:137], v[124:125], v[70:71] op_sel:[0,0] op_sel_hi:[1,0]
    v_pk_mul_f32 v[138:139], v[128:129], v[70:71] op_sel:[0,0] op_sel_hi:[1,0]
    v_pk_mul_f32 v[142:143], v[124:125], v[72:73] op_sel:[0,0] op_sel_hi:[1,0]
    v_pk_fma_f32 v[136:137], v[124:125], v[70:71], v[136:137] op_sel:[1,1,0] op_sel_hi:[0,1,1] neg_lo:[1,0,0]
    v_pk_fma_f32 v[138:139], v[128:129], v[70:71], v[138:139] op_sel:[1,1,0] op_sel_hi:[0,1,1] neg_lo:[1,0,0]
    v_pk_fma_f32 v[142:143], v[124:125], v[72:73], v[142:143] op_sel:[1,1,0] op_sel_hi:[0,1,1] neg_lo:[1,0,0]
    v_cvt_pk_bf16_f32 v90, v152, v153
    v_cvt_pk_bf16_f32 v91, v154, v155
    v_cvt_pk_bf16_f32 v84, v190, -v191
    ds_write_b32 v236, v90 offset:9792
    ds_write_b32 v236, v91 offset:10336
    ds_write_b32 v236, v84 offset:20128
    v_pk_mul_f32 v[176:177], v[174:175], v[160:161] op_sel:[0,0] op_sel_hi:[1,0]
    v_pk_mul_f32 v[178:179], v[174:175], v[162:163] op_sel:[0,0] op_sel_hi:[1,0]
    v_pk_mul_f32 v[180:181], v[174:175], v[164:165] op_sel:[0,0] op_sel_hi:[1,0]
    v_pk_fma_f32 v[176:177], v[174:175], v[160:161], v[176:177] op_sel:[1,1,0] op_sel_hi:[0,1,1] neg_lo:[1,0,0]
    v_pk_fma_f32 v[178:179], v[174:175], v[162:163], v[178:179] op_sel:[1,1,0] op_sel_hi:[0,1,1] neg_lo:[1,0,0]
    v_pk_fma_f32 v[180:181], v[174:175], v[164:165], v[180:181] op_sel:[1,1,0] op_sel_hi:[0,1,1] neg_lo:[1,0,0]
    v_cvt_pk_bf16_f32 v85, v136, v137
    v_cvt_pk_bf16_f32 v86, v138, v139
    v_cvt_pk_bf16_f32 v87, v142, v143
    ds_write_b32 v236, v85 offset:5440
    ds_write_b32 v236, v86 offset:5984
    ds_write_b32 v236, v87 offset:7072
    v_pk_mul_f32 v[182:183], v[174:175], v[166:167] op_sel:[0,0] op_sel_hi:[1,0]
    v_pk_mul_f32 v[184:185], v[174:175], v[168:169] op_sel:[0,0] op_sel_hi:[1,0]
    v_pk_mul_f32 v[186:187], v[174:175], v[170:171] op_sel:[0,0] op_sel_hi:[1,0]
    v_pk_fma_f32 v[182:183], v[174:175], v[166:167], v[182:183] op_sel:[1,1,0] op_sel_hi:[0,1,1] neg_lo:[1,0,0]
    v_pk_fma_f32 v[184:185], v[174:175], v[168:169], v[184:185] op_sel:[1,1,0] op_sel_hi:[0,1,1] neg_lo:[1,0,0]
    v_pk_fma_f32 v[186:187], v[174:175], v[170:171], v[186:187] op_sel:[1,1,0] op_sel_hi:[0,1,1] neg_lo:[1,0,0]
    v_cvt_pk_bf16_f32 v88, v176, -v177
    v_cvt_pk_bf16_f32 v89, v178, -v179
    v_cvt_pk_bf16_f32 v90, v180, -v181
    ds_write_b32 v236, v88 offset:16320
    ds_write_b32 v236, v89 offset:16864
    ds_write_b32 v236, v90 offset:17408
    v_pk_mul_f32 v[188:189], v[174:175], v[172:173] op_sel:[0,0] op_sel_hi:[1,0]
    v_pk_fma_f32 v[188:189], v[174:175], v[172:173], v[188:189] op_sel:[1,1,0] op_sel_hi:[0,1,1] neg_lo:[1,0,0]
    v_cvt_pk_bf16_f32 v91, v182, -v183
    v_cvt_pk_bf16_f32 v84, v184, -v185
    v_cvt_pk_bf16_f32 v85, v186, -v187
    ds_write_b32 v236, v91 offset:17952
    ds_write_b32 v236, v84 offset:18496
    ds_write_b32 v236, v85 offset:19040
    v_pk_mul_f32 v[146:147], v[136:137], v[72:73] op_sel:[0,0] op_sel_hi:[1,0]
    v_pk_mul_f32 v[156:157], v[148:149], v[74:75] op_sel:[0,0] op_sel_hi:[1,0]
    v_pk_mul_f32 v[192:193], v[190:191], v[160:161] op_sel:[0,0] op_sel_hi:[1,0]
    v_pk_fma_f32 v[146:147], v[136:137], v[72:73], v[146:147] op_sel:[1,1,0] op_sel_hi:[0,1,1] neg_lo:[1,0,0]
    v_pk_fma_f32 v[156:157], v[148:149], v[74:75], v[156:157] op_sel:[1,1,0] op_sel_hi:[0,1,1] neg_lo:[1,0,0]
    v_pk_fma_f32 v[192:193], v[190:191], v[160:161], v[192:193] op_sel:[1,1,0] op_sel_hi:[0,1,1] neg_lo:[1,0,0]
    v_cvt_pk_bf16_f32 v86, v188, -v189
    ds_write_b32 v236, v86 offset:19584
    v_pk_mul_f32 v[194:195], v[190:191], v[162:163] op_sel:[0,0] op_sel_hi:[1,0]
    v_pk_mul_f32 v[196:197], v[190:191], v[164:165] op_sel:[0,0] op_sel_hi:[1,0]
    v_pk_mul_f32 v[198:199], v[190:191], v[166:167] op_sel:[0,0] op_sel_hi:[1,0]
    v_pk_fma_f32 v[194:195], v[190:191], v[162:163], v[194:195] op_sel:[1,1,0] op_sel_hi:[0,1,1] neg_lo:[1,0,0]
    v_pk_fma_f32 v[196:197], v[190:191], v[164:165], v[196:197] op_sel:[1,1,0] op_sel_hi:[0,1,1] neg_lo:[1,0,0]
    v_pk_fma_f32 v[198:199], v[190:191], v[166:167], v[198:199] op_sel:[1,1,0] op_sel_hi:[0,1,1] neg_lo:[1,0,0]
    v_cvt_pk_bf16_f32 v87, v146, v147
    v_cvt_pk_bf16_f32 v88, v156, v157
    v_cvt_pk_bf16_f32 v89, v192, -v193
    ds_write_b32 v236, v87 offset:8160
    ds_write_b32 v236, v88 offset:10880
    ds_write_b32 v236, v89 offset:20672
    v_pk_mul_f32 v[200:201], v[190:191], v[168:169] op_sel:[0,0] op_sel_hi:[1,0]
    v_pk_mul_f32 v[202:203], v[190:191], v[170:171] op_sel:[0,0] op_sel_hi:[1,0]
    v_pk_mul_f32 v[204:205], v[190:191], v[172:173] op_sel:[0,0] op_sel_hi:[1,0]
    v_pk_fma_f32 v[200:201], v[190:191], v[168:169], v[200:201] op_sel:[1,1,0] op_sel_hi:[0,1,1] neg_lo:[1,0,0]
    v_pk_fma_f32 v[202:203], v[190:191], v[170:171], v[202:203] op_sel:[1,1,0] op_sel_hi:[0,1,1] neg_lo:[1,0,0]
    v_pk_fma_f32 v[204:205], v[190:191], v[172:173], v[204:205] op_sel:[1,1,0] op_sel_hi:[0,1,1] neg_lo:[1,0,0]
    v_cvt_pk_bf16_f32 v90, v194, -v195
    v_cvt_pk_bf16_f32 v91, v196, -v197
    v_cvt_pk_bf16_f32 v84, v198, -v199
    ds_write_b32 v236, v90 offset:21216
    ds_write_b32 v236, v91 offset:21760
    ds_write_b32 v236, v84 offset:22304
    v_pk_mul_f32 v[206:207], v[190:191], v[174:175] op_sel:[0,0] op_sel_hi:[1,0]
    v_pk_mul_f32 v[208:209], v[190:191], v[176:177] op_sel:[0,0] op_sel_hi:[1,0]
    v_pk_mul_f32 v[210:211], v[190:191], v[178:179] op_sel:[0,0] op_sel_hi:[1,0]
    v_pk_fma_f32 v[206:207], v[190:191], v[174:175], v[206:207] op_sel:[1,1,0] op_sel_hi:[0,1,1] neg_lo:[1,0,0]
    v_pk_fma_f32 v[208:209], v[190:191], v[176:177], v[208:209] op_sel:[1,1,0] op_sel_hi:[0,1,1] neg_lo:[1,0,0]
    v_pk_fma_f32 v[210:211], v[190:191], v[178:179], v[210:211] op_sel:[1,1,0] op_sel_hi:[0,1,1] neg_lo:[1,0,0]
    v_cvt_pk_bf16_f32 v85, v200, -v201
    v_cvt_pk_bf16_f32 v86, v202, -v203
    v_cvt_pk_bf16_f32 v87, v204, -v205
    ds_write_b32 v236, v85 offset:22848
    ds_write_b32 v236, v86 offset:23392
    ds_write_b32 v236, v87 offset:23936
    v_pk_mul_f32 v[212:213], v[190:191], v[180:181] op_sel:[0,0] op_sel_hi:[1,0]
    v_pk_mul_f32 v[214:215], v[190:191], v[182:183] op_sel:[0,0] op_sel_hi:[1,0]
    v_pk_mul_f32 v[216:217], v[190:191], v[184:185] op_sel:[0,0] op_sel_hi:[1,0]
    v_pk_fma_f32 v[212:213], v[190:191], v[180:181], v[212:213] op_sel:[1,1,0] op_sel_hi:[0,1,1] neg_lo:[1,0,0]
    v_pk_fma_f32 v[214:215], v[190:191], v[182:183], v[214:215] op_sel:[1,1,0] op_sel_hi:[0,1,1] neg_lo:[1,0,0]
    v_pk_fma_f32 v[216:217], v[190:191], v[184:185], v[216:217] op_sel:[1,1,0] op_sel_hi:[0,1,1] neg_lo:[1,0,0]
    v_cvt_pk_bf16_f32 v88, v206, -v207
    v_cvt_pk_bf16_f32 v89, v208, -v209
    v_cvt_pk_bf16_f32 v90, v210, -v211
    ds_write_b32 v236, v88 offset:24480
    ds_write_b32 v236, v89 offset:25024
    ds_write_b32 v236, v90 offset:25568
    v_pk_mul_f32 v[218:219], v[190:191], v[186:187] op_sel:[0,0] op_sel_hi:[1,0]
    v_pk_mul_f32 v[220:221], v[190:191], v[188:189] op_sel:[0,0] op_sel_hi:[1,0]
    v_pk_fma_f32 v[218:219], v[190:191], v[186:187], v[218:219] op_sel:[1,1,0] op_sel_hi:[0,1,1] neg_lo:[1,0,0]
    v_pk_fma_f32 v[220:221], v[190:191], v[188:189], v[220:221] op_sel:[1,1,0] op_sel_hi:[0,1,1] neg_lo:[1,0,0]
    v_cvt_pk_bf16_f32 v91, v212, -v213
    v_cvt_pk_bf16_f32 v84, v214, -v215
    v_cvt_pk_bf16_f32 v85, v216, -v217
    ds_write_b32 v236, v91 offset:26112
    ds_write_b32 v236, v84 offset:26656
    ds_write_b32 v236, v85 offset:27200
    v_cvt_pk_bf16_f32 v86, v218, -v219
    v_cvt_pk_bf16_f32 v87, v220, -v221
    ds_write_b32 v236, v86 offset:27744
    ds_write_b32 v236, v87 offset:28288
    s_cmp_lt_u32 s2, 128
    s_cbranch_scc1 L_xt1
    s_lshl_b32 s4, s3, 12
    s_mul_i32 s5, s2, 16640
    s_add_u32 s4, s4, s5
    s_add_u32 s4, s4, 0x800000
    buffer_store_dwordx4 v[16:19], v251, s[52:55], s4 offen offset:0 sc1
    buffer_store_dwordx4 v[20:23], v251, s[52:55], s4 offen offset:1024 sc1
    buffer_store_dwordx4 v[24:27], v251, s[52:55], s4 offen offset:2048 sc1
    buffer_store_dwordx4 v[28:31], v251, s[52:55], s4 offen offset:3072 sc1
L_xt1:
    s_nop 1
    s_waitcnt lgkmcnt(0)
    s_barrier
    ds_read_b128 v[128:131], v238 offset:11424
    ds_read_b128 v[132:135], v237 offset:0
    ds_read_b128 v[136:139], v237 offset:8704
    ds_read_b128 v[140:143], v238 offset:11488
    ds_read_b128 v[144:147], v237 offset:64
    ds_read_b128 v[148:151], v237 offset:8768
    ds_read_b128 v[152:155], v238 offset:11552
    ds_read_b128 v[156:159], v237 offset:128
    ds_read_b128 v[160:163], v237 offset:8832
    ds_read_b128 v[164:167], v238 offset:11616
    ds_read_b128 v[168:171], v237 offset:192
    ds_read_b128 v[172:175], v237 offset:8896
    ds_read_b128 v[176:179], v238 offset:11680
    ds_read_b128 v[180:183], v237 offset:256
    ds_read_b128 v[184:187], v237 offset:8960
    s_waitcnt lgkmcnt(12)
    v_mfma_f32_16x16x32_bf16 v[64:67], v[132:135], v[128:131], 0
    v_mfma_f32_16x16x32_bf16 v[68:71], v[136:139], v[128:131], 0
    ds_read_b128 v[128:131], v238 offset:11744
    ds_read_b128 v[132:135], v237 offset:320
    ds_read_b128 v[136:139], v237 offset:9024
    s_waitcnt lgkmcnt(12)
    v_mfma_f32_16x16x32_bf16 v[64:67], v[144:147], v[140:143], v[64:67]
    v_mfma_f32_16x16x32_bf16 v[68:71], v[148:151], v[140:143], v[68:71]
    ds_read_b128 v[140:143], v238 offset:11808
    ds_read_b128 v[144:147], v237 offset:384
    ds_read_b128 v[148:151], v237 offset:9088
    s_waitcnt lgkmcnt(12)
    v_mfma_f32_16x16x32_bf16 v[64:67], v[156:159], v[152:155], v[64:67]
    v_mfma_f32_16x16x32_bf16 v[68:71], v[160:163], v[152:155], v[68:71]
    ds_read_b128 v[152:155], v238 offset:11872
    ds_read_b128 v[156:159], v237 offset:448
    ds_read_b128 v[160:163], v237 offset:9152
    s_waitcnt lgkmcnt(12)
    v_mfma_f32_16x16x32_bf16 v[64:67], v[168:171], v[164:167], v[64:67]
    v_mfma_f32_16x16x32_bf16 v[68:71], v[172:175], v[164:167], v[68:71]
    s_waitcnt lgkmcnt(9)
    v_mfma_f32_16x16x32_bf16 v[64:67], v[180:183], v[176:179], v[64:67]
    v_mfma_f32_16x16x32_bf16 v[68:71], v[184:187], v[176:179], v[68:71]
    s_waitcnt lgkmcnt(6)
    v_mfma_f32_16x16x32_bf16 v[64:67], v[132:135], v[128:131], v[64:67]
    v_mfma_f32_16x16x32_bf16 v[68:71], v[136:139], v[128:131], v[68:71]
    s_waitcnt lgkmcnt(3)
    v_mfma_f32_16x16x32_bf16 v[64:67], v[144:147], v[140:143], v[64:67]
    v_mfma_f32_16x16x32_bf16 v[68:71], v[148:151], v[140:143], v[68:71]
    s_waitcnt lgkmcnt(0)
    v_mfma_f32_16x16x32_bf16 v[64:67], v[156:159], v[152:155], v[64:67]
    v_mfma_f32_16x16x32_bf16 v[68:71], v[160:163], v[152:155], v[68:71]
    s_nop 6
    s_nop 0
    v_pk_mul_f32 v[64:65], v[64:65], v[14:15] op_sel:[0,1] op_sel_hi:[1,1]
    v_pk_mul_f32 v[66:67], v[66:67], v[14:15] op_sel:[0,1] op_sel_hi:[1,1]
    v_pk_mul_f32 v[68:69], v[68:69], v[14:15] op_sel:[0,1] op_sel_hi:[1,1]
    v_pk_mul_f32 v[70:71], v[70:71], v[14:15] op_sel:[0,1] op_sel_hi:[1,1]
    v_cvt_pk_bf16_f32 v72, v64, v65
    v_cvt_pk_bf16_f32 v73, v66, v67
    v_cvt_pk_bf16_f32 v74, v68, v69
    v_cvt_pk_bf16_f32 v75, v70, v71
    ds_write_b32 v239, v72
    ds_write_b32 v240, v73
    ds_write_b16 v241, v74 offset:1024
    ds_write_b16_d16_hi v241, v74 offset:1088
    ds_write_b16 v241, v75 offset:1152
    ds_write_b16_d16_hi v241, v75 offset:1216
    s_lshl_b32 s57, s3, 11
    s_lshl_b32 s56, s75, 6
    s_mul_i32 s62, s3, 532480
    s_add_u32 s56, s56, s62
    s_add_u32 s56, s56, 0x800000
    s_add_u32 s62, s56, 266240
    s_add_u32 s57, s57, 0x1000
    s_lshl_b32 s58, s75, 4
    s_add_u32 s58, s58, 0x20000
    buffer_load_dwordx2 v[2:3], v5, s[52:55], s58 offen sc1
    buffer_load_dwordx4 v[200:203], v251, s[52:55], s57 offen offset:0 sc1
    buffer_load_dwordx4 v[204:207], v251, s[52:55], s57 offen offset:1024 sc1
    buffer_load_dwordx4 v[192:195], v59, s[52:55], s56 offen sc1
    buffer_load_dwordx4 v[196:199], v59, s[52:55], s62 offen sc1
    s_waitcnt lgkmcnt(0)
    s_barrier
    ds_read_u16 v128, v50
    ds_read_u16 v129, v51
    ds_read_u16 v130, v52
    ds_read_u16 v131, v53
    ds_read_u16 v132, v54
    ds_read_u16 v133, v55
    ds_read_u16 v134, v56
    ds_read_u16 v135, v57
    ds_read_u16 v136, v58
    ds_read_u16 v144, v50 offset:2112
    ds_read_u16 v145, v51 offset:2112
    ds_read_u16 v146, v52 offset:2112
    ds_read_u16 v147, v53 offset:2112
    ds_read_u16 v148, v54 offset:2112
    s_waitcnt lgkmcnt(5)
    s_nop 0
    ds_read_u16 v149, v55 offset:2112
    ds_read_u16 v150, v56 offset:2112
    ds_read_u16 v151, v57 offset:2112
    ds_read_u16 v152, v58 offset:2112
    v_lshl_or_b32 v160, v129, 16, v128
    v_lshl_or_b32 v164, v130, 16, v129
    v_lshl_or_b32 v161, v131, 16, v130
    v_lshl_or_b32 v165, v132, 16, v131
    v_lshl_or_b32 v162, v133, 16, v132
    v_lshl_or_b32 v166, v134, 16, v133
    v_lshl_or_b32 v163, v135, 16, v134
    v_lshl_or_b32 v167, v136, 16, v135
    s_waitcnt lgkmcnt(0)
    s_nop 0
    ds_write_b128 v252, v[160:163] offset:4224
    ds_write_b128 v252, v[164:167] offset:8384
    v_lshl_or_b32 v168, v145, 16, v144
    v_lshl_or_b32 v172, v146, 16, v145
    v_lshl_or_b32 v169, v147, 16, v146
    v_lshl_or_b32 v173, v148, 16, v147
    v_lshl_or_b32 v170, v149, 16, v148
    v_lshl_or_b32 v174, v150, 16, v149
    v_lshl_or_b32 v171, v151, 16, v150
    v_lshl_or_b32 v175, v152, 16, v151
    ds_write_b128 v252, v[168:171] offset:12544
    ds_write_b128 v252, v[172:175] offset:16704
    s_waitcnt vmcnt(5)
    s_nop 0
    s_mov_b32 s6, 0x05040100
    s_mov_b32 s7, 0x07060302
    v_perm_b32 v208, v98, v96, s6
    v_perm_b32 v209, v102, v100, s6
    v_perm_b32 v210, v106, v104, s6
    v_perm_b32 v211, v110, v108, s6
    buffer_store_dwordx4 v[208:211], v251, s[52:55], s73 offen sc1
    s_add_u32 s73, s73, 0x4000
    v_perm_b32 v212, v98, v96, s7
    v_perm_b32 v213, v102, v100, s7
    v_perm_b32 v214, v106, v104, s7
    v_perm_b32 v215, v110, v108, s7
    buffer_store_dwordx4 v[212:215], v251, s[52:55], s73 offen sc1
    s_add_u32 s73, s73, 0x4000
    v_perm_b32 v216, v99, v97, s6
    v_perm_b32 v217, v103, v101, s6
    v_perm_b32 v218, v107, v105, s6
    v_perm_b32 v219, v111, v109, s6
    buffer_store_dwordx4 v[216:219], v251, s[52:55], s73 offen sc1
    s_add_u32 s73, s73, 0x4000
    v_perm_b32 v220, v99, v97, s7
    v_perm_b32 v221, v103, v101, s7
    v_perm_b32 v222, v107, v105, s7
    v_perm_b32 v223, v111, v109, s7
    buffer_store_dwordx4 v[220:223], v251, s[52:55], s73 offen sc1
    s_waitcnt vmcnt(4)
L_sw0_chk:
    s_nop 0
    v_min3_u32 v60, v193, v195, s72
    v_max3_u32 v61, v193, v195, s72
    v_min3_u32 v60, v197, v199, v60
    v_max3_u32 v61, v197, v199, v61
    v_min3_u32 v60, v201, v203, v60
    v_max3_u32 v61, v201, v203, v61
    v_min3_u32 v60, v205, v207, v60
    v_max3_u32 v61, v205, v207, v61
    v_min3_u32 v60, v3, v3, v60
    v_max3_u32 v61, v3, v3, v61
    v_cmp_ne_u32 vcc, v60, v61
    s_cbranch_vccz L_sw0_ok
    s_sub_u32 s12, s12, 1
    s_cmp_lt_i32 s12, 0
    s_cbranch_scc1 L_sw0_ok
    s_sleep 4
    buffer_load_dwordx2 v[2:3], v5, s[52:55], s58 offen sc1
    buffer_load_dwordx4 v[200:203], v251, s[52:55], s57 offen offset:0 sc1
    buffer_load_dwordx4 v[204:207], v251, s[52:55], s57 offen offset:1024 sc1
    buffer_load_dwordx4 v[192:195], v59, s[52:55], s56 offen sc1
    buffer_load_dwordx4 v[196:199], v59, s[52:55], s62 offen sc1
    s_waitcnt vmcnt(0)
    s_branch L_sw0_chk
L_sw0_ok:
    s_waitcnt lgkmcnt(4)
    v_add_f32_dpp v2, v2, v2 quad_perm:[1,0,3,2] row_mask:0xf bank_mask:0xf
    v_lshlrev_b32 v128, 16, v200
    v_lshlrev_b32 v130, 16, v202
    v_lshlrev_b32 v132, 16, v204
    v_lshlrev_b32_e64 v134, 16, v206
    v_add_f32_dpp v2, v2, v2 quad_perm:[2,3,0,1] row_mask:0xf bank_mask:0xf
    v_rcp_f32 v128, v128
    v_rcp_f32 v130, v130
    v_cvt_pk_bf16_f32 v2, v2, v2
    v_lshlrev_b32 v2, 16, v2
    v_add_f32 v2, v2, v4
    v_cvt_pk_bf16_f32 v3, v2, v2
    v_rcp_f32 v132, v132
    v_rcp_f32 v134, v134
    v_lshlrev_b32_e64 v2, 16, v3
    v_and_b32 v129, 0xffff0000, v200
    v_readlane_b32 s82, v2, 8
    v_readlane_b32 s83, v2, 12
    v_and_b32 v131, 0xffff0000, v202
    v_readlane_b32 s80, v2, 0
    v_readlane_b32 s81, v2, 4
    v_and_b32 v133, 0xffff0000, v204
    v_readlane_b32 s84, v2, 16
    v_readlane_b32 s85, v2, 20
    v_and_b32 v135, 0xffff0000, v206
    v_readlane_b32 s86, v2, 32
    v_readlane_b32 s87, v2, 36
    v_lshlrev_b32_e64 v136, 16, v192
    v_and_b32 v137, 0xffff0000, v192
    v_lshlrev_b32_e64 v138, 16, v194
    v_and_b32 v139, 0xffff0000, v194
    v_lshlrev_b32_e64 v140, 16, v196
    v_and_b32 v141, 0xffff0000, v196
    v_lshlrev_b32_e64 v142, 16, v198
    v_and_b32 v143, 0xffff0000, v198
    v_lshlrev_b32_e64 v156, 1, v253
    v_pk_add_f32 v[136:137], v[136:137], v[128:129] op_sel:[0,1] op_sel_hi:[1,1] neg_lo:[0,1] neg_hi:[0,1]
    v_pk_mul_f32 v[144:145], s[82:83], v[128:129] op_sel:[0,0] op_sel_hi:[1,0]
    v_pk_add_f32 v[138:139], v[138:139], v[130:131] op_sel:[0,1] op_sel_hi:[1,1] neg_lo:[0,1] neg_hi:[0,1]
    v_pk_mul_f32 v[146:147], s[82:83], v[130:131] op_sel:[0,0] op_sel_hi:[1,0]
    v_pk_add_f32 v[140:141], v[140:141], v[132:133] op_sel:[0,1] op_sel_hi:[1,1] neg_lo:[0,1] neg_hi:[0,1]
    v_pk_mul_f32 v[148:149], s[82:83], v[132:133] op_sel:[0,0] op_sel_hi:[1,0]
    v_pk_add_f32 v[142:143], v[142:143], v[134:135] op_sel:[0,1] op_sel_hi:[1,1] neg_lo:[0,1] neg_hi:[0,1]
    v_pk_mul_f32 v[150:151], s[82:83], v[134:135] op_sel:[0,0] op_sel_hi:[1,0]
    v_pk_fma_f32 v[144:145], v[136:137], v[144:145], s[80:81]
    v_pk_fma_f32 v[146:147], v[138:139], v[146:147], s[80:81]
    v_pk_fma_f32 v[148:149], v[140:141], v[148:149], s[80:81]
    v_pk_fma_f32 v[150:151], v[142:143], v[150:151], s[80:81]
    v_cvt_pk_bf16_f32 v152, v144, v146
    v_cvt_pk_bf16_f32 v153, v145, v147
    ds_write_b32 v253, v152 offset:21344
    ds_write_b32 v253, v153 offset:25952
    v_cvt_pk_bf16_f32 v154, v148, v150
    v_cvt_pk_bf16_f32 v155, v149, v151
    ds_write_b32 v253, v154 offset:21600
    ds_write_b32 v253, v155 offset:26208
    v_mov_b32_e64 v193, v194
    ds_write_b64 v156, v[192:193] offset:30080
    v_mov_b32_e64 v197, v198
    ds_write_b64 v156, v[196:197] offset:30592
    s_waitcnt lgkmcnt(0)
    s_barrier
    ds_read2_b32 a[128:129], v242 offset0:224 offset1:225
    ds_read2_b32 a[130:131], v242 offset0:226 offset1:227
    ds_read_b128 a[12:15], v246 offset:384
    ds_read_b128 a[28:31], v246 offset:896
    ds_read_b128 a[44:47], v246 offset:1408
    ds_read_b128 a[60:63], v246 offset:1920
    ds_read2_b32 a[132:133], v242 offset0:192 offset1:193
    ds_read2_b32 a[134:135], v242 offset0:194 offset1:195
    ds_read_b128 a[8:11], v246 offset:256
    ds_read_b128 a[24:27], v246 offset:768
    ds_read_b128 a[40:43], v246 offset:1280
    ds_read_b128 a[56:59], v246 offset:1792
    ds_read2_b32 a[136:137], v242 offset0:160 offset1:161
    ds_read2_b32 a[138:139], v242 offset0:162 offset1:163
    ds_read_b128 a[4:7], v246 offset:128
    s_waitcnt lgkmcnt(12)
    v_mfma_f32_16x16x32_bf16 v[96:99], a[128:131], a[12:15], 0
    ds_read_b128 a[20:23], v246 offset:640
    ds_read_b128 a[36:39], v246 offset:1152
    s_waitcnt lgkmcnt(13)
    v_mfma_f32_16x16x32_bf16 v[100:103], a[128:131], a[28:31], 0
    ds_read_b128 a[52:55], v246 offset:1664
    ds_read2_b32 a[140:141], v242 offset0:128 offset1:129
    s_waitcnt lgkmcnt(14)
    v_mfma_f32_16x16x32_bf16 v[104:107], a[128:131], a[44:47], 0
    buffer_load_dwordx2 v[208:209], v232, s[68:71], s11 offen nt
    ds_read2_b32 a[142:143], v242 offset0:130 offset1:131
    s_waitcnt lgkmcnt(14)
    v_mfma_f32_16x16x32_bf16 v[108:111], a[128:131], a[60:63], 0
    ds_read_b128 a[0:3], v246 offset:0
    s_waitcnt lgkmcnt(12)
    v_mfma_f32_16x16x32_bf16 v[96:99], a[132:135], a[8:11], v[96:99]
    s_add_u32 s11, s11, 0x2000
    buffer_load_dwordx2 v[210:211], v232, s[68:71], s11 offen nt
    ds_read_b128 a[16:19], v246 offset:512
    ds_read_b128 a[32:35], v246 offset:1024
    s_waitcnt lgkmcnt(13)
    v_mfma_f32_16x16x32_bf16 v[100:103], a[132:135], a[24:27], v[100:103]
    ds_read_b128 a[48:51], v246 offset:1536
    ds_read2_b32 a[144:145], v242 offset0:96 offset1:97
    s_waitcnt lgkmcnt(14)
    v_mfma_f32_16x16x32_bf16 v[104:107], a[132:135], a[40:43], v[104:107]
    s_add_u32 s11, s11, 0x2000
    buffer_load_dwordx2 v[212:213], v232, s[68:71], s11 offen nt
    ds_read2_b32 a[146:147], v242 offset0:98 offset1:99
    s_waitcnt lgkmcnt(14)
    v_mfma_f32_16x16x32_bf16 v[108:111], a[132:135], a[56:59], v[108:111]
    ds_read2_b32 a[148:149], v242 offset0:64 offset1:65
    s_waitcnt lgkmcnt(12)
    v_mfma_f32_16x16x32_bf16 v[96:99], a[136:139], a[4:7], v[96:99]
    s_add_u32 s11, s11, 0x2000
    buffer_load_dwordx2 v[214:215], v232, s[68:71], s11 offen nt
    ds_read2_b32 a[150:151], v242 offset0:66 offset1:67
    ds_read2_b32 a[152:153], v242 offset0:32 offset1:33
    s_waitcnt lgkmcnt(13)
    v_mfma_f32_16x16x32_bf16 v[100:103], a[136:139], a[20:23], v[100:103]
    ds_read2_b32 a[154:155], v242 offset0:34 offset1:35
    ds_read2_b32 a[156:157], v242 offset0:0 offset1:1
    s_waitcnt lgkmcnt(14)
    v_mfma_f32_16x16x32_bf16 v[104:107], a[136:139], a[36:39], v[104:107]
    s_add_u32 s11, s11, 0x2000
    buffer_load_dwordx2 v[216:217], v232, s[68:71], s11 offen nt
    ds_read2_b32 a[158:159], v242 offset0:2 offset1:3
    s_waitcnt lgkmcnt(14)
    v_mfma_f32_16x16x32_bf16 v[108:111], a[136:139], a[52:55], v[108:111]
    ds_read2_b32 a[160:161], v243 offset0:224 offset1:225
    s_waitcnt lgkmcnt(12)
    v_mfma_f32_16x16x32_bf16 v[96:99], a[140:143], a[0:3], v[96:99]
    s_add_u32 s11, s11, 0x2000
    buffer_load_dwordx2 v[218:219], v232, s[68:71], s11 offen nt
    ds_read2_b32 a[162:163], v243 offset0:226 offset1:227
    ds_read2_b32 a[164:165], v243 offset0:192 offset1:193
    s_waitcnt lgkmcnt(13)
    v_mfma_f32_16x16x32_bf16 v[100:103], a[140:143], a[16:19], v[100:103]
    ds_read2_b32 a[166:167], v243 offset0:194 offset1:195
    ds_read2_b32 a[168:169], v243 offset0:160 offset1:161
    s_waitcnt lgkmcnt(14)
    v_mfma_f32_16x16x32_bf16 v[104:107], a[140:143], a[32:35], v[104:107]
    s_add_u32 s11, s11, 0x2000
    buffer_load_dwordx2 v[220:221], v232, s[68:71], s11 offen nt
    ds_read2_b32 a[170:171], v243 offset0:162 offset1:163
    s_waitcnt lgkmcnt(14)
    v_mfma_f32_16x16x32_bf16 v[108:111], a[140:143], a[48:51], v[108:111]
    ds_read2_b32 a[172:173], v243 offset0:128 offset1:129
    s_waitcnt lgkmcnt(13)
    v_mfma_f32_16x16x32_bf16 v[100:103], a[144:147], a[12:15], v[100:103]
    s_add_u32 s11, s11, 0x2000
    buffer_load_dwordx2 v[222:223], v232, s[68:71], s11 offen nt
    ds_read2_b32 a[174:175], v243 offset0:130 offset1:131
    ds_read2_b32 a[176:177], v243 offset0:96 offset1:97
    v_mfma_f32_16x16x32_bf16 v[104:107], a[144:147], a[28:31], v[104:107]
    v_mfma_f32_16x16x32_bf16 v[108:111], a[144:147], a[44:47], v[108:111]
    v_mov_b32_dpp v4, v2 row_shl:4 row_mask:0xf bank_mask:0xf
    s_mov_b32 s95, 0xffff
    s_waitcnt lgkmcnt(13)
    v_mfma_f32_16x16x32_bf16 v[100:103], a[148:151], a[8:11], v[100:103]
    ds_read2_b32 a[178:179], v243 offset0:98 offset1:99
    ds_read2_b32 a[180:181], v243 offset0:64 offset1:65
    v_mfma_f32_16x16x32_bf16 v[104:107], a[148:151], a[24:27], v[104:107]
    v_and_or_b32 v2, v3, s95, v4
    v_mov_b32_e64 v3, s72
    v_mfma_f32_16x16x32_bf16 v[108:111], a[148:151], a[40:43], v[108:111]
    s_waitcnt lgkmcnt(13)
    v_mfma_f32_16x16x32_bf16 v[100:103], a[152:155], a[4:7], v[100:103]
    s_lshl_b32 s4, s75, 3
    s_add_u32 s4, s4, 0x9000
    s_mov_b32 exec_lo, 0x1000000
    s_mov_b32 exec_hi, 0x101
    buffer_store_dwordx2 v[2:3], v7, s[52:55], s4 offen sc1
    s_mov_b64 exec, -1
    ds_read2_b32 a[182:183], v243 offset0:66 offset1:67
    ds_read2_b32 a[184:185], v243 offset0:32 offset1:33
    v_mfma_f32_16x16x32_bf16 v[104:107], a[152:155], a[20:23], v[104:107]
    v_mfma_f32_16x16x32_bf16 v[108:111], a[152:155], a[36:39], v[108:111]
    v_lshlrev_b32 v4, 16, v48
    v_and_b32 v5, 0xffff0000, v48
    s_waitcnt lgkmcnt(13)
    v_mfma_f32_16x16x32_bf16 v[100:103], a[156:159], a[0:3], v[100:103]
    ds_read2_b32 a[186:187], v243 offset0:34 offset1:35
    ds_read2_b32 a[188:189], v243 offset0:0 offset1:1
    v_mfma_f32_16x16x32_bf16 v[104:107], a[156:159], a[16:19], v[104:107]
    v_mfma_f32_16x16x32_bf16 v[108:111], a[156:159], a[32:35], v[108:111]
    s_waitcnt lgkmcnt(13)
    v_mfma_f32_16x16x32_bf16 v[104:107], a[160:163], a[12:15], v[104:107]
    ds_read2_b32 a[190:191], v243 offset0:2 offset1:3
    v_mfma_f32_16x16x32_bf16 v[108:111], a[160:163], a[28:31], v[108:111]
    s_waitcnt lgkmcnt(12)
    v_mfma_f32_16x16x32_bf16 v[104:107], a[164:167], a[8:11], v[104:107]
    s_waitcnt vmcnt(9)
    v_mov_b32 v60, s72
    s_mov_b64 exec, 1
    buffer_store_dword v60, off, s[52:55], s88 offset:0 sc1
    s_mov_b64 exec, -1
    v_mfma_f32_16x16x32_bf16 v[108:111], a[164:167], a[24:27], v[108:111]
    s_waitcnt lgkmcnt(10)
    v_mfma_f32_16x16x32_bf16 v[104:107], a[168:171], a[4:7], v[104:107]
    v_mfma_f32_16x16x32_bf16 v[108:111], a[168:171], a[20:23], v[108:111]
    s_waitcnt lgkmcnt(8)
    v_mfma_f32_16x16x32_bf16 v[104:107], a[172:175], a[0:3], v[104:107]
    v_mfma_f32_16x16x32_bf16 v[108:111], a[172:175], a[16:19], v[108:111]
    s_waitcnt lgkmcnt(6)
    v_mfma_f32_16x16x32_bf16 v[108:111], a[176:179], a[12:15], v[108:111]
    s_waitcnt lgkmcnt(4)
    v_mfma_f32_16x16x32_bf16 v[108:111], a[180:183], a[8:11], v[108:111]
    s_waitcnt lgkmcnt(2)
    v_mfma_f32_16x16x32_bf16 v[108:111], a[184:187], a[4:7], v[108:111]
    s_waitcnt lgkmcnt(0)
    v_mfma_f32_16x16x32_bf16 v[108:111], a[188:191], a[0:3], v[108:111]
    s_nop 0
    v_add_u32 v62, 135168, v247
    v_add_u32 v63, 135168, v248
    ds_read_b64 v[16:17], v249 offset:21344
    ds_read_b64 v[18:19], v249 offset:25952
    ds_read_b128 v[20:23], v250 offset:30080
    ds_write_b128 v62, v[96:99] offset:0
    ds_write_b128 v62, v[100:103] offset:1280
    ds_write_b128 v62, v[104:107] offset:2560
    ds_write_b128 v62, v[108:111] offset:3840
    s_waitcnt lgkmcnt(4)
    v_lshlrev_b32 v128, 16, v16
    v_and_b32 v129, 0xffff0000, v16
    v_lshlrev_b32_e64 v130, 16, v17
    v_and_b32 v131, 0xffff0000, v17
    v_lshlrev_b32_e64 v132, 16, v18
    v_and_b32 v133, 0xffff0000, v18
    v_lshlrev_b32_e64 v134, 16, v19
    v_and_b32 v135, 0xffff0000, v19
    v_lshlrev_b32_e64 v136, 16, v20
    v_and_b32 v140, 0xffff0000, v20
    v_lshlrev_b32_e64 v137, 16, v21
    v_and_b32 v141, 0xffff0000, v21
    v_lshlrev_b32_e64 v138, 16, v22
    v_and_b32 v142, 0xffff0000, v22
    v_lshlrev_b32_e64 v139, 16, v23
    v_and_b32 v143, 0xffff0000, v23
    v_pk_mul_f32 v[128:129], v[128:129], v[4:5] op_sel:[0,0] op_sel_hi:[1,0]
    v_pk_mul_f32 v[130:131], v[130:131], v[4:5] op_sel:[0,0] op_sel_hi:[1,0]
    v_pk_mul_f32 v[132:133], v[132:133], v[4:5] op_sel:[0,1] op_sel_hi:[1,1]
    v_pk_mul_f32 v[134:135], v[134:135], v[4:5] op_sel:[0,1] op_sel_hi:[1,1]
    v_pk_fma_f32 v[136:137], v[128:129], s[84:85], v[136:137] op_sel:[0,0,0] op_sel_hi:[1,0,1]
    v_pk_fma_f32 v[138:139], v[130:131], s[84:85], v[138:139] op_sel:[0,0,0] op_sel_hi:[1,0,1]
    v_pk_fma_f32 v[140:141], v[132:133], s[84:85], v[140:141] op_sel:[0,1,0] op_sel_hi:[1,1,1]
    v_pk_fma_f32 v[142:143], v[134:135], s[84:85], v[142:143] op_sel:[0,1,0] op_sel_hi:[1,1,1]
    s_mul_i32 s4, s75, 8320
    s_lshl_b32 s5, s3, 10
    s_add_u32 s4, s4, s5
    s_add_u32 s5, s4, 0x540000
    s_mul_i32 s4, s3, 266240
    s_lshl_b32 s6, s75, 6
    s_add_u32 s4, s4, s6
    s_add_u32 s4, s4, 0x300000
    s_waitcnt lgkmcnt(0)
    s_barrier
    ds_read_b128 v[144:147], v63 offset:0
    ds_read_b128 v[148:151], v63 offset:5120
    ds_read_b128 v[152:155], v63 offset:10240
    ds_read_b128 v[156:159], v63 offset:15360
    s_waitcnt lgkmcnt(2)
    v_pk_add_f32 v[144:145], v[144:145], v[148:149]
    v_pk_add_f32 v[146:147], v[146:147], v[150:151]
    s_waitcnt lgkmcnt(0)
    v_pk_add_f32 v[152:153], v[152:153], v[156:157]
    v_pk_add_f32 v[154:155], v[154:155], v[158:159]
    v_pk_fma_f32 v[144:145], v[144:145], s[84:85], v[136:137] op_sel:[0,0,0] op_sel_hi:[1,0,1]
    v_pk_fma_f32 v[146:147], v[146:147], s[84:85], v[138:139] op_sel:[0,0,0] op_sel_hi:[1,0,1]
    v_pk_fma_f32 v[152:153], v[152:153], s[84:85], v[140:141] op_sel:[0,1,0] op_sel_hi:[1,1,1]
    v_pk_fma_f32 v[154:155], v[154:155], s[84:85], v[142:143] op_sel:[0,1,0] op_sel_hi:[1,1,1]
    v_cvt_pk_bf16_f32 v160, v144, v152
    v_cvt_pk_bf16_f32 v161, v145, v153
    v_cvt_pk_bf16_f32 v162, v146, v154
    v_cvt_pk_bf16_f32 v163, v147, v155
    v_lshlrev_b32_e64 v164, 16, v160
    v_and_b32 v165, 0xffff0000, v160
    v_lshlrev_b32_e64 v166, 16, v161
    v_and_b32 v167, 0xffff0000, v161
    v_lshlrev_b32_e64 v168, 16, v162
    v_and_b32 v169, 0xffff0000, v162
    v_lshlrev_b32_e64 v170, 16, v163
    v_and_b32 v171, 0xffff0000, v163
    v_pk_mul_f32 v[164:165], v[164:165], s[86:87]
    v_pk_mul_f32 v[166:167], v[166:167], s[86:87]
    v_pk_mul_f32 v[168:169], v[168:169], s[86:87]
    v_pk_mul_f32 v[170:171], v[170:171], s[86:87]
    v_cvt_pk_bf16_f32 v172, v164, v165
    v_cvt_pk_bf16_f32 v173, v166, v167
    v_cvt_pk_bf16_f32 v174, v168, v169
    v_cvt_pk_bf16_f32 v175, v170, v171
    buffer_store_dwordx4 v[172:175], v251, s[52:55], s5 offen sc1
    buffer_store_dwordx4 v[160:163], v59, s[52:55], s4 offen sc1
    ds_read2_b32 a[192:193], v244 offset0:224 offset1:225
    ds_read2_b32 a[194:195], v244 offset0:226 offset1:227
    ds_read2_b32 a[196:197], v244 offset0:192 offset1:193
    ds_read2_b32 a[198:199], v244 offset0:194 offset1:195
    ds_read2_b32 a[200:201], v244 offset0:160 offset1:161
    ds_read2_b32 a[202:203], v244 offset0:162 offset1:163
    ds_read2_b32 a[204:205], v244 offset0:128 offset1:129
    ds_read2_b32 a[206:207], v244 offset0:130 offset1:131
    ds_read2_b32 a[208:209], v244 offset0:96 offset1:97
    ds_read2_b32 a[210:211], v244 offset0:98 offset1:99
    ds_read2_b32 a[212:213], v244 offset0:64 offset1:65
    ds_read2_b32 a[214:215], v244 offset0:66 offset1:67
    ds_read2_b32 a[216:217], v244 offset0:32 offset1:33
    ds_read2_b32 a[218:219], v244 offset0:34 offset1:35
    ds_read2_b32 a[220:221], v244 offset0:0 offset1:1
    v_mfma_f32_16x16x32_bf16 v[112:115], a[144:147], a[60:63], 0
    s_mov_b32 s16, 0x0
    s_mov_b32 s17, 0x20800
    v_mfma_f32_16x16x32_bf16 v[112:115], a[148:151], a[56:59], v[112:115]
    s_mov_b32 s18, 0x41000
    s_mov_b32 s19, 0x61800
    v_mfma_f32_16x16x32_bf16 v[112:115], a[152:155], a[52:55], v[112:115]
    s_mov_b32 s20, 0x82000
    s_mov_b32 s21, 0xa2800
    v_mfma_f32_16x16x32_bf16 v[112:115], a[156:159], a[48:51], v[112:115]
    s_mov_b32 s22, 0xc3000
    s_mov_b32 s23, 0xe3800
    v_mfma_f32_16x16x32_bf16 v[112:115], a[160:163], a[44:47], v[112:115]
    s_mov_b32 s24, 0x104000
    s_mov_b32 s25, 0x124800
    v_mfma_f32_16x16x32_bf16 v[116:119], a[160:163], a[60:63], 0
    s_mov_b32 s26, 0x145000
    s_mov_b32 s27, 0x165800
    v_mfma_f32_16x16x32_bf16 v[112:115], a[164:167], a[40:43], v[112:115]
    s_mov_b32 s28, 0x186000
    s_mov_b32 s29, 0x1a6800
    v_mfma_f32_16x16x32_bf16 v[116:119], a[164:167], a[56:59], v[116:119]
    s_mov_b32 s30, 0x1c7000
    s_mov_b32 s31, 0x1e7800
    v_mfma_f32_16x16x32_bf16 v[112:115], a[168:171], a[36:39], v[112:115]
    s_movk_i32 s32, 0x0
    s_movk_i32 s33, 0x1000
    v_mfma_f32_16x16x32_bf16 v[116:119], a[168:171], a[52:55], v[116:119]
    s_movk_i32 s34, 0x2000
    s_movk_i32 s35, 0x3000
    v_mfma_f32_16x16x32_bf16 v[112:115], a[172:175], a[32:35], v[112:115]
    s_lshl_b32 s4, s76, 5
    s_add_u32 s4, s4, s77
    v_mfma_f32_16x16x32_bf16 v[116:119], a[172:175], a[48:51], v[116:119]
    s_lshl_b32 s61, s4, 5
    s_lshl_b32 s5, s3, 2
    v_mfma_f32_16x16x32_bf16 v[112:115], a[176:179], a[28:31], v[112:115]
    s_add_u32 s61, s61, s5
    s_add_u32 s61, s61, 0x1e000
    v_mfma_f32_16x16x32_bf16 v[116:119], a[176:179], a[44:47], v[116:119]
    s_mul_i32 s4, s90, 229376
    s_mul_i32 s5, s3, 14336
    v_mfma_f32_16x16x32_bf16 v[120:123], a[176:179], a[60:63], 0
    s_add_u32 s4, s4, s5
    s_add_u32 s4, s4, 0x100000
    v_mfma_f32_16x16x32_bf16 v[112:115], a[180:183], a[24:27], v[112:115]
    v_add_u32 v12, s4, v251
    v_add_u32 v13, 57344, v12
    v_mfma_f32_16x16x32_bf16 v[116:119], a[180:183], a[40:43], v[116:119]
    v_add_u32 v14, 114688, v12
    v_add_u32 v15, 172032, v12
    v_mfma_f32_16x16x32_bf16 v[120:123], a[180:183], a[56:59], v[120:123]
    v_add_u32 v10, 40960, v251
    v_add_u32 v11, 106496, v251
    v_mfma_f32_16x16x32_bf16 v[112:115], a[184:187], a[20:23], v[112:115]
    v_lshrrev_b32 v62, 3, v1
    v_and_b32 v63, 7, v1
    v_mfma_f32_16x16x32_bf16 v[116:119], a[184:187], a[36:39], v[116:119]
    v_lshlrev_b32_e64 v63, 4, v63
    v_mul_u32_u24 v8, 16640, v62
    v_mfma_f32_16x16x32_bf16 v[120:123], a[184:187], a[52:55], v[120:123]
    v_add_u32_e64 v8, v8, v63
    s_add_u32 s4, s79, 0x540000
    v_mfma_f32_16x16x32_bf16 v[112:115], a[188:191], a[16:19], v[112:115]
    v_add_u32_e64 v8, s4, v8
    v_add_u32 v9, 8320, v8
    v_mfma_f32_16x16x32_bf16 v[116:119], a[188:191], a[32:35], v[116:119]
    s_lshl_b32 s59, s89, 7
    s_mul_i32 s5, s3, 1863680
    v_mfma_f32_16x16x32_bf16 v[120:123], a[188:191], a[48:51], v[120:123]
    s_add_u32 s59, s59, s5
    s_add_u32 s59, s59, 0xd00000
    s_waitcnt lgkmcnt(13)
    v_mfma_f32_16x16x32_bf16 v[112:115], a[192:195], a[12:15], v[112:115]
    s_sub_u32 s59, s59, s4
    ds_read2_b32 a[222:223], v244 offset0:2 offset1:3
    v_mfma_f32_16x16x32_bf16 v[116:119], a[192:195], a[28:31], v[116:119]
    v_and_b32_e64 v62, 8, v1
    ds_read2_b32 a[224:225], v245 offset0:224 offset1:225
    v_mfma_f32_16x16x32_bf16 v[120:123], a[192:195], a[44:47], v[120:123]
    v_add_u32 v63, v63, v62
    v_lshlrev_b32 v239, 1, v63
    v_mfma_f32_16x16x32_bf16 v[124:127], a[192:195], a[60:63], 0
    v_lshrrev_b32_e64 v62, 4, v1
    v_mul_u32_u24 v232, 8320, v62
    s_waitcnt lgkmcnt(13)
    v_mfma_f32_16x16x32_bf16 v[112:115], a[196:199], a[8:11], v[112:115]
    v_add_u32 v232, v232, v63
    ds_read2_b32 a[226:227], v245 offset0:226 offset1:227
    v_mfma_f32_16x16x32_bf16 v[116:119], a[196:199], a[24:27], v[116:119]
    v_lshlrev_b32_e64 v235, 3, v62
    ds_read2_b32 a[228:229], v245 offset0:192 offset1:193
    v_mfma_f32_16x16x32_bf16 v[120:123], a[196:199], a[40:43], v[120:123]
    s_lshl_b32 s4, s3, 5
    s_add_u32 s4, s4, 160000
    v_mfma_f32_16x16x32_bf16 v[124:127], a[196:199], a[56:59], v[124:127]
    v_add_u32 v235, s4, v235
    v_and_b32 v233, 48, v1
    s_waitcnt lgkmcnt(13)
    v_mfma_f32_16x16x32_bf16 v[112:115], a[200:203], a[4:7], v[112:115]
    v_add_u32 v233, 157696, v233
    ds_read2_b32 a[230:231], v245 offset0:194 offset1:195
    v_mfma_f32_16x16x32_bf16 v[116:119], a[200:203], a[20:23], v[116:119]
    v_lshlrev_b32_e64 v234, 6, v0
    ds_read2_b32 a[232:233], v245 offset0:160 offset1:161
    v_mfma_f32_16x16x32_bf16 v[120:123], a[200:203], a[36:39], v[120:123]
    v_and_b32 v237, 3, v1
    v_lshlrev_b32 v236, 2, v237
    v_mfma_f32_16x16x32_bf16 v[124:127], a[200:203], a[52:55], v[124:127]
    v_add_u32 v236, 160000, v236
    v_lshlrev_b32 v237, 3, v237
    s_waitcnt lgkmcnt(13)
    v_mfma_f32_16x16x32_bf16 v[112:115], a[204:207], a[0:3], v[112:115]
    v_mul_u32_u24_e64 v238, 16, v1
    ds_read2_b32 a[234:235], v245 offset0:162 offset1:163
    v_mfma_f32_16x16x32_bf16 v[116:119], a[204:207], a[16:19], v[116:119]
    v_and_b32_e64 v241, 31, v1
    ds_read2_b32 a[236:237], v245 offset0:128 offset1:129
    v_mfma_f32_16x16x32_bf16 v[120:123], a[204:207], a[32:35], v[120:123]
    v_lshlrev_b32 v240, 5, v241
    s_lshl_b32 s4, s76, 9
    v_mfma_f32_16x16x32_bf16 v[124:127], a[204:207], a[48:51], v[124:127]
    s_lshl_b32 s5, s77, 4
    s_add_u32 s92, s4, s5
    s_waitcnt lgkmcnt(13)
    v_mfma_f32_16x16x32_bf16 v[116:119], a[208:211], a[12:15], v[116:119]
    s_lshr_b32 s4, s92, 6
    ds_read2_b32 a[238:239], v245 offset0:130 offset1:131
    v_mfma_f32_16x16x32_bf16 v[120:123], a[208:211], a[28:31], v[120:123]
    s_mul_i32 s4, s4, 16640
    ds_read2_b32 a[240:241], v245 offset0:96 offset1:97
    v_mfma_f32_16x16x32_bf16 v[124:127], a[208:211], a[44:47], v[124:127]
    s_and_b32 s5, s92, 63
    s_add_u32 s60, s4, s5
    s_waitcnt lgkmcnt(13)
    v_mfma_f32_16x16x32_bf16 v[116:119], a[212:215], a[8:11], v[116:119]
    s_lshl_b32 s94, s79, 1
    ds_read2_b32 a[242:243], v245 offset0:98 offset1:99
    v_mfma_f32_16x16x32_bf16 v[120:123], a[212:215], a[24:27], v[120:123]
    s_add_u32 s94, s94, 0x5000
    ds_read2_b32 a[244:245], v245 offset0:64 offset1:65
    v_mfma_f32_16x16x32_bf16 v[124:127], a[212:215], a[40:43], v[124:127]
    s_lshr_b32 s4, s89, 2
    s_lshl_b32 s93, s4, 10
    s_waitcnt lgkmcnt(13)
    v_mfma_f32_16x16x32_bf16 v[116:119], a[216:219], a[4:7], v[116:119]
    s_nop 0
    s_add_u32 s56, s56, 2129920
    s_add_u32 s62, s62, 2129920
    s_add_u32 s57, s57, 0x2000
    buffer_load_dwordx4 v[184:187], v251, s[52:55], s57 offen offset:0 sc1
    buffer_load_dwordx4 v[188:191], v251, s[52:55], s57 offen offset:1024 sc1
    buffer_load_dwordx4 v[176:179], v59, s[52:55], s56 offen sc1
    buffer_load_dwordx4 v[180:183], v59, s[52:55], s62 offen sc1
    ds_read2_b32 a[246:247], v245 offset0:66 offset1:67
    v_mfma_f32_16x16x32_bf16 v[120:123], a[216:219], a[20:23], v[120:123]
    s_add_u32 s93, s93, 0x1e000
    ds_read2_b32 a[248:249], v245 offset0:32 offset1:33
    v_mfma_f32_16x16x32_bf16 v[124:127], a[216:219], a[36:39], v[124:127]
    s_mov_b32 s42, 0x00ff00ff
    s_mov_b32 s43, 0x00ff00ff
    s_waitcnt lgkmcnt(13)
    v_mfma_f32_16x16x32_bf16 v[116:119], a[220:223], a[0:3], v[116:119]
    s_mov_b32 s44, 0xff00ff00
    ds_read2_b32 a[250:251], v245 offset0:34 offset1:35
    v_mfma_f32_16x16x32_bf16 v[120:123], a[220:223], a[16:19], v[120:123]
    s_mov_b32 s45, 0xff00ff00
    ds_read2_b32 a[252:253], v245 offset0:0 offset1:1
    v_mfma_f32_16x16x32_bf16 v[124:127], a[220:223], a[32:35], v[124:127]
    s_waitcnt lgkmcnt(13)
    v_mfma_f32_16x16x32_bf16 v[120:123], a[224:227], a[12:15], v[120:123]
    ds_read2_b32 a[254:255], v245 offset0:2 offset1:3
    v_mfma_f32_16x16x32_bf16 v[124:127], a[224:227], a[28:31], v[124:127]
    s_waitcnt lgkmcnt(12)
    v_mfma_f32_16x16x32_bf16 v[120:123], a[228:231], a[8:11], v[120:123]
    v_mfma_f32_16x16x32_bf16 v[124:127], a[228:231], a[24:27], v[124:127]
    s_waitcnt lgkmcnt(10)
    v_mfma_f32_16x16x32_bf16 v[120:123], a[232:235], a[4:7], v[120:123]
    v_mfma_f32_16x16x32_bf16 v[124:127], a[232:235], a[20:23], v[124:127]
    s_waitcnt lgkmcnt(8)
    v_mfma_f32_16x16x32_bf16 v[120:123], a[236:239], a[0:3], v[120:123]
    s_waitcnt vmcnt(4)
    s_barrier
    s_cmp_lg_u32 s3, 0
    s_cbranch_scc1 L_fxa
    v_mov_b32_e64 v60, s72
    s_mov_b64 exec, 1
    buffer_store_dword v60, off, s[52:55], s38 sc1
    s_mov_b64 exec, -1
L_fxa:
    v_mfma_f32_16x16x32_bf16 v[124:127], a[236:239], a[16:19], v[124:127]
    s_mul_i32 s74, s77, 7
    s_and_b32 s74, s74, 0xf8
    v_and_b32 v254, 15, v1
    v_add_u32 v254, s74, v254
    v_min_u32 v254, 0xdf, v254
    v_lshlrev_b32_e64 v254, 7, v254
    s_mov_b32 s74, 0x10000
    buffer_load_dwordx4 v[36:39], v254, s[52:55], s74 offen sc1
    s_waitcnt lgkmcnt(6)
    v_mfma_f32_16x16x32_bf16 v[124:127], a[240:243], a[12:15], v[124:127]
    s_waitcnt lgkmcnt(4)
    v_mfma_f32_16x16x32_bf16 v[124:127], a[244:247], a[8:11], v[124:127]
    s_waitcnt lgkmcnt(2)
    v_mfma_f32_16x16x32_bf16 v[124:127], a[248:251], a[4:7], v[124:127]
    s_waitcnt lgkmcnt(0)
    v_mfma_f32_16x16x32_bf16 v[124:127], a[252:255], a[0:3], v[124:127]
    s_mov_b32 s6, 0x05040100
    s_mov_b32 s7, 0x07060302
    v_perm_b32 v160, v210, v208, s6
    v_perm_b32 v161, v214, v212, s6
    v_perm_b32 v162, v218, v216, s6
    v_perm_b32 v163, v222, v220, s6
    buffer_store_dwordx4 v[160:163], v224, s[52:55], s13 offen sc1
    s_add_u32 s13, s13, 57344
    v_perm_b32 v164, v210, v208, s7
    v_perm_b32 v165, v214, v212, s7
    v_perm_b32 v166, v218, v216, s7
    v_perm_b32 v167, v222, v220, s7
    buffer_store_dwordx4 v[164:167], v224, s[52:55], s13 offen sc1
    s_add_u32 s13, s13, 57344
    v_perm_b32 v168, v211, v209, s6
    v_perm_b32 v169, v215, v213, s6
    v_perm_b32 v170, v219, v217, s6
    v_perm_b32 v171, v223, v221, s6
    buffer_store_dwordx4 v[168:171], v224, s[52:55], s13 offen sc1
    s_add_u32 s13, s13, 57344
    v_perm_b32 v172, v211, v209, s7
    v_perm_b32 v173, v215, v213, s7
    v_perm_b32 v174, v219, v217, s7
    v_perm_b32 v175, v223, v221, s7
    buffer_store_dwordx4 v[172:175], v224, s[52:55], s13 offen sc1
    s_waitcnt vmcnt(5)
L_sw1_chk:
    s_nop 0
    v_min3_u32 v60, v177, v179, s72
    v_max3_u32 v61, v177, v179, s72
    v_min3_u32 v60, v181, v183, v60
    v_max3_u32 v61, v181, v183, v61
    v_min3_u32 v60, v185, v187, v60
    v_max3_u32 v61, v185, v187, v61
    v_min3_u32 v60, v189, v191, v60
    v_max3_u32 v61, v189, v191, v61
    v_cmp_ne_u32 vcc, v60, v61
    s_cbranch_vccz L_sw1_ok
    s_sub_u32 s12, s12, 1
    s_cmp_lt_i32 s12, 0
    s_cbranch_scc1 L_sw1_ok
    s_sleep 4
    buffer_load_dwordx4 v[184:187], v251, s[52:55], s57 offen offset:0 sc1
    buffer_load_dwordx4 v[188:191], v251, s[52:55], s57 offen offset:1024 sc1
    buffer_load_dwordx4 v[176:179], v59, s[52:55], s56 offen sc1
    buffer_load_dwordx4 v[180:183], v59, s[52:55], s62 offen sc1
    s_waitcnt vmcnt(0)
    s_branch L_sw1_chk
L_sw1_ok:
    v_lshlrev_b32 v128, 16, v184
    v_lshlrev_b32 v130, 16, v186
    v_lshlrev_b32 v132, 16, v188
    v_lshlrev_b32 v134, 16, v190
    v_rcp_f32 v128, v128
    v_rcp_f32 v130, v130
    v_rcp_f32 v132, v132
    v_rcp_f32 v134, v134
    v_and_b32 v129, 0xffff0000, v184
    v_and_b32 v131, 0xffff0000, v186
    v_and_b32 v133, 0xffff0000, v188
    v_and_b32 v135, 0xffff0000, v190
    v_lshlrev_b32_e64 v136, 16, v176
    v_and_b32 v137, 0xffff0000, v176
    v_lshlrev_b32_e64 v138, 16, v178
    v_and_b32 v139, 0xffff0000, v178
    v_lshlrev_b32_e64 v140, 16, v180
    v_and_b32 v141, 0xffff0000, v180
    v_lshlrev_b32_e64 v142, 16, v182
    v_and_b32 v143, 0xffff0000, v182
    v_lshlrev_b32_e64 v156, 1, v253
    v_pk_add_f32 v[136:137], v[136:137], v[128:129] op_sel:[0,1] op_sel_hi:[1,1] neg_lo:[0,1] neg_hi:[0,1]
    v_pk_mul_f32 v[144:145], s[82:83], v[128:129] op_sel:[0,0] op_sel_hi:[1,0]
    v_pk_add_f32 v[138:139], v[138:139], v[130:131] op_sel:[0,1] op_sel_hi:[1,1] neg_lo:[0,1] neg_hi:[0,1]
    v_pk_mul_f32 v[146:147], s[82:83], v[130:131] op_sel:[0,0] op_sel_hi:[1,0]
    v_pk_add_f32 v[140:141], v[140:141], v[132:133] op_sel:[0,1] op_sel_hi:[1,1] neg_lo:[0,1] neg_hi:[0,1]
    v_pk_mul_f32 v[148:149], s[82:83], v[132:133] op_sel:[0,0] op_sel_hi:[1,0]
    v_pk_add_f32 v[142:143], v[142:143], v[134:135] op_sel:[0,1] op_sel_hi:[1,1] neg_lo:[0,1] neg_hi:[0,1]
    v_pk_mul_f32 v[150:151], s[82:83], v[134:135] op_sel:[0,0] op_sel_hi:[1,0]
    v_pk_fma_f32 v[144:145], v[136:137], v[144:145], s[80:81]
    v_pk_fma_f32 v[146:147], v[138:139], v[146:147], s[80:81]
    v_pk_fma_f32 v[148:149], v[140:141], v[148:149], s[80:81]
    v_pk_fma_f32 v[150:151], v[142:143], v[150:151], s[80:81]
    v_cvt_pk_bf16_f32 v152, v144, v146
    v_cvt_pk_bf16_f32 v153, v145, v147
    ds_write_b32 v253, v152 offset:23392
    ds_write_b32 v253, v153 offset:28000
    v_cvt_pk_bf16_f32 v154, v148, v150
    v_cvt_pk_bf16_f32 v155, v149, v151
    ds_write_b32 v253, v154 offset:23648
    ds_write_b32 v253, v155 offset:28256
    v_mov_b32_e64 v177, v178
    ds_write_b64 v156, v[176:177] offset:34176
    v_mov_b32_e64 v181, v182
    ds_write_b64 v156, v[180:181] offset:34688
    s_or_b32 s4, s2, s3
    s_cmp_lg_u32 s4, 0
    s_cbranch_scc1 L_noep
    v_mov_b32_e64 v60, s72
    s_mov_b64 exec, 1
    buffer_store_dword v60, off, s[52:55], 0 offset:0 sc1
    s_mov_b64 exec, -1
L_noep:
    s_waitcnt vmcnt(4)
L_rp1_chk:
    v_min3_u32 v60, v36, v37, s72
    v_max3_u32 v61, v36, v37, s72
    v_min3_u32 v60, v38, v39, v60
    v_max3_u32 v61, v38, v39, v61
    v_cmp_ne_u32 vcc, v60, v61
    s_cbranch_vccz L_rp1_ok
    s_sub_u32 s12, s12, 1
    s_cmp_lt_i32 s12, 0
    s_cbranch_scc1 L_rp1_ok
    s_sleep 4
    buffer_load_dwordx4 v[36:39], v254, s[52:55], s74 offen sc1
    s_waitcnt vmcnt(0)
    s_branch L_rp1_chk
L_rp1_ok:
    s_mul_i32 s4, s77, 114688
    s_add_u32 s4, s4, 0x14f6000
    v_add_u32 v255, s4, v251
    s_lshl_b32 s5, s3, 10
    s_add_u32 m0, s5, 40960
    s_nop 0
    buffer_load_dwordx4 v255, s[52:55], m0 offen sc1 lds
    s_add_u32 m0, m0, 0x1000
    s_nop 0
    buffer_load_dwordx4 v255, s[52:55], m0 offen sc1 lds
    s_add_u32 m0, m0, 0x1000
    s_nop 0
    buffer_load_dwordx4 v255, s[52:55], m0 offen sc1 lds
    s_add_u32 m0, m0, 0x1000
    s_nop 0
    buffer_load_dwordx4 v255, s[52:55], m0 offen sc1 lds
    s_waitcnt lgkmcnt(0)
    s_barrier
    s_add_u32 s63, s38, 0x1000
    ds_read_b128 a[76:79], v246 offset:2432
    ds_read_b128 a[92:95], v246 offset:2944
    ds_read_b128 a[108:111], v246 offset:3456
    ds_read_b128 a[124:127], v246 offset:3968
    ds_read_b128 a[72:75], v246 offset:2304
    ds_read_b128 a[88:91], v246 offset:2816
    ds_read_b128 a[104:107], v246 offset:3328
    ds_read_b128 a[120:123], v246 offset:3840
    ds_read_b128 a[68:71], v246 offset:2176
    ds_read_b128 a[84:87], v246 offset:2688
    ds_read_b128 a[100:103], v246 offset:3200
    ds_read_b128 a[116:119], v246 offset:3712
    ds_read_b128 a[64:67], v246 offset:2048
    ds_read_b128 a[80:83], v246 offset:2560
    ds_read_b128 a[96:99], v246 offset:3072
    s_waitcnt lgkmcnt(14)
    v_mfma_f32_16x16x32_bf16 v[112:115], a[128:131], a[76:79], v[112:115]
    ds_read_b128 a[112:115], v246 offset:3584
    s_waitcnt lgkmcnt(14)
    v_mfma_f32_16x16x32_bf16 v[116:119], a[128:131], a[92:95], v[116:119]
    s_add_u32 m0, m0, 0x1000
    s_nop 0
    buffer_load_dwordx4 v255, s[52:55], m0 offen sc1 lds
    s_waitcnt lgkmcnt(13)
    v_mfma_f32_16x16x32_bf16 v[120:123], a[128:131], a[108:111], v[120:123]
    s_waitcnt lgkmcnt(12)
    v_mfma_f32_16x16x32_bf16 v[124:127], a[128:131], a[124:127], v[124:127]
    s_waitcnt lgkmcnt(11)
    v_mfma_f32_16x16x32_bf16 v[112:115], a[132:135], a[72:75], v[112:115]
    s_add_u32 m0, m0, 0x1000
    s_nop 0
    buffer_load_dwordx4 v255, s[52:55], m0 offen sc1 lds
    s_waitcnt lgkmcnt(10)
    v_mfma_f32_16x16x32_bf16 v[116:119], a[132:135], a[88:91], v[116:119]
    s_waitcnt lgkmcnt(9)
    v_mfma_f32_16x16x32_bf16 v[120:123], a[132:135], a[104:107], v[120:123]
    s_waitcnt lgkmcnt(8)
    v_mfma_f32_16x16x32_bf16 v[124:127], a[132:135], a[120:123], v[124:127]
    s_add_u32 m0, m0, 0x1000
    s_nop 0
    buffer_load_dwordx4 v255, s[52:55], m0 offen sc1 lds
    s_waitcnt lgkmcnt(7)
    v_mfma_f32_16x16x32_bf16 v[112:115], a[136:139], a[68:71], v[112:115]
    s_waitcnt lgkmcnt(6)
    v_mfma_f32_16x16x32_bf16 v[116:119], a[136:139], a[84:87], v[116:119]
    s_waitcnt lgkmcnt(5)
    v_mfma_f32_16x16x32_bf16 v[120:123], a[136:139], a[100:103], v[120:123]
    s_add_u32 m0, m0, 0x1000
    s_nop 0
    buffer_load_dwordx4 v255, s[52:55], m0 offen sc1 lds
    s_waitcnt lgkmcnt(4)
    v_mfma_f32_16x16x32_bf16 v[124:127], a[136:139], a[116:119], v[124:127]
    s_waitcnt lgkmcnt(3)
    v_mfma_f32_16x16x32_bf16 v[112:115], a[140:143], a[64:67], v[112:115]
    s_waitcnt lgkmcnt(2)
    v_mfma_f32_16x16x32_bf16 v[116:119], a[140:143], a[80:83], v[116:119]
    s_add_u32 m0, m0, 0x1000
    s_nop 0
    buffer_load_dwordx4 v255, s[52:55], m0 offen sc1 lds
    s_waitcnt lgkmcnt(1)
    v_mfma_f32_16x16x32_bf16 v[120:123], a[140:143], a[96:99], v[120:123]
    s_waitcnt lgkmcnt(0)
    v_mfma_f32_16x16x32_bf16 v[124:127], a[140:143], a[112:115], v[124:127]
    v_mfma_f32_16x16x32_bf16 v[116:119], a[144:147], a[76:79], v[116:119]
    s_add_u32 m0, m0, 0x1000
    s_nop 0
    buffer_load_dwordx4 v255, s[52:55], m0 offen sc1 lds
    v_mfma_f32_16x16x32_bf16 v[120:123], a[144:147], a[92:95], v[120:123]
    v_mfma_f32_16x16x32_bf16 v[124:127], a[144:147], a[108:111], v[124:127]
    v_mfma_f32_16x16x32_bf16 v[116:119], a[148:151], a[72:75], v[116:119]
    s_add_u32 m0, m0, 0x1000
    s_nop 0
    buffer_load_dwordx4 v255, s[52:55], m0 offen sc1 lds
    v_mfma_f32_16x16x32_bf16 v[120:123], a[148:151], a[88:91], v[120:123]
    v_mfma_f32_16x16x32_bf16 v[124:127], a[148:151], a[104:107], v[124:127]
    v_mfma_f32_16x16x32_bf16 v[116:119], a[152:155], a[68:71], v[116:119]
    s_add_u32 m0, m0, 0x1000
    s_nop 0
    buffer_load_dwordx4 v255, s[52:55], m0 offen sc1 lds
    v_mfma_f32_16x16x32_bf16 v[120:123], a[152:155], a[84:87], v[120:123]
    v_mfma_f32_16x16x32_bf16 v[124:127], a[152:155], a[100:103], v[124:127]
    v_mfma_f32_16x16x32_bf16 v[116:119], a[156:159], a[64:67], v[116:119]
    s_add_u32 m0, m0, 0x1000
    s_nop 0
    buffer_load_dwordx4 v255, s[52:55], m0 offen sc1 lds
    v_mfma_f32_16x16x32_bf16 v[120:123], a[156:159], a[80:83], v[120:123]
    v_mfma_f32_16x16x32_bf16 v[124:127], a[156:159], a[96:99], v[124:127]
    v_mfma_f32_16x16x32_bf16 v[120:123], a[160:163], a[76:79], v[120:123]
    s_add_u32 m0, m0, 0x1000
    s_nop 0
    buffer_load_dwordx4 v255, s[52:55], m0 offen sc1 lds
    v_mfma_f32_16x16x32_bf16 v[124:127], a[160:163], a[92:95], v[124:127]
    v_mfma_f32_16x16x32_bf16 v[120:123], a[164:167], a[72:75], v[120:123]
    v_mfma_f32_16x16x32_bf16 v[124:127], a[164:167], a[88:91], v[124:127]
    s_add_u32 m0, m0, 0x1000
    s_nop 0
    buffer_load_dwordx4 v255, s[52:55], m0 offen sc1 lds
    v_mfma_f32_16x16x32_bf16 v[120:123], a[168:171], a[68:71], v[120:123]
    v_mfma_f32_16x16x32_bf16 v[124:127], a[168:171], a[84:87], v[124:127]
    v_mfma_f32_16x16x32_bf16 v[120:123], a[172:175], a[64:67], v[120:123]
    s_add_u32 m0, m0, 0x1000
    s_nop 0
    buffer_load_dwordx4 v255, s[52:55], m0 offen sc1 lds
    v_mfma_f32_16x16x32_bf16 v[124:127], a[172:175], a[80:83], v[124:127]
    v_mfma_f32_16x16x32_bf16 v[124:127], a[176:179], a[76:79], v[124:127]
    v_mfma_f32_16x16x32_bf16 v[124:127], a[180:183], a[72:75], v[124:127]
    s_add_u32 m0, m0, 0x1000
    s_nop 0
    buffer_load_dwordx4 v255, s[52:55], m0 offen sc1 lds
    v_mfma_f32_16x16x32_bf16 v[124:127], a[184:187], a[68:71], v[124:127]
    v_mfma_f32_16x16x32_bf16 v[124:127], a[188:191], a[64:67], v[124:127]
    s_add_u32 m0, m0, 0x1000
    s_nop 0
    buffer_load_dwordx4 v255, s[52:55], m0 offen sc1 lds
    s_add_u32 m0, m0, 0x1000
    s_nop 0
    buffer_load_dwordx4 v255, s[52:55], m0 offen sc1 lds
    s_add_u32 m0, m0, 0x1000
    s_nop 0
    buffer_load_dwordx4 v255, s[52:55], m0 offen sc1 lds
    s_add_u32 m0, m0, 0x1000
    s_nop 0
    buffer_load_dwordx4 v255, s[52:55], m0 offen sc1 lds
    s_add_u32 m0, m0, 0x1000
    s_nop 0
    buffer_load_dwordx4 v255, s[52:55], m0 offen sc1 lds
    s_add_u32 m0, m0, 0x1000
    s_nop 0
    buffer_load_dwordx4 v255, s[52:55], m0 offen sc1 lds
    s_add_u32 m0, m0, 0x1000
    s_nop 0
    buffer_load_dwordx4 v255, s[52:55], m0 offen sc1 lds
    s_add_u32 m0, m0, 0x1000
    s_nop 0
    buffer_load_dwordx4 v255, s[52:55], m0 offen sc1 lds
    s_add_u32 m0, m0, 0x1000
    s_nop 0
    buffer_load_dwordx4 v255, s[52:55], m0 offen sc1 lds
    s_add_u32 m0, m0, 0x1000
    s_nop 0
    buffer_load_dwordx4 v255, s[52:55], m0 offen sc1 lds
    s_add_u32 m0, m0, 0x1000
    s_nop 0
    buffer_load_dwordx4 v255, s[52:55], m0 offen sc1 lds
    s_mov_b32 s95, 0x9000
    buffer_load_dwordx4 v[32:35], v252, s[52:55], s95 offen sc1
    buffer_load_dwordx4 v[200:203], v238, s[52:55], s36 offen sc1
    ds_read_b64 v[16:17], v249 offset:23392
    ds_read_b64 v[18:19], v249 offset:28000
    ds_read_b128 v[20:23], v250 offset:34176
    s_waitcnt vmcnt(30)
    s_waitcnt lgkmcnt(0)
    s_barrier
    s_cmp_lg_u32 s3, 0
    s_cbranch_scc1 L_fr2
    v_mov_b32_e64 v60, s72
    s_mov_b64 exec, 1
    buffer_store_dword v60, off, s[52:55], s63 sc1
    s_mov_b64 exec, -1
L_fr2:
    ds_write_b128 v247, v[112:115] offset:0
    ds_write_b128 v247, v[116:119] offset:1280
    ds_write_b128 v247, v[120:123] offset:2560
    ds_write_b128 v247, v[124:127] offset:3840
    v_lshlrev_b32 v128, 16, v16
    v_and_b32 v129, 0xffff0000, v16
    v_lshlrev_b32_e64 v130, 16, v17
    v_and_b32 v131, 0xffff0000, v17
    v_lshlrev_b32_e64 v132, 16, v18
    v_and_b32 v133, 0xffff0000, v18
    v_lshlrev_b32_e64 v134, 16, v19
    v_and_b32 v135, 0xffff0000, v19
    v_lshlrev_b32_e64 v136, 16, v20
    v_and_b32 v140, 0xffff0000, v20
    v_lshlrev_b32_e64 v137, 16, v21
    v_and_b32 v141, 0xffff0000, v21
    v_lshlrev_b32_e64 v138, 16, v22
    v_and_b32 v142, 0xffff0000, v22
    v_lshlrev_b32_e64 v139, 16, v23
    v_and_b32 v143, 0xffff0000, v23
    v_pk_mul_f32 v[128:129], v[128:129], v[4:5] op_sel:[0,0] op_sel_hi:[1,0]
    v_pk_mul_f32 v[130:131], v[130:131], v[4:5] op_sel:[0,0] op_sel_hi:[1,0]
    v_pk_mul_f32 v[132:133], v[132:133], v[4:5] op_sel:[0,1] op_sel_hi:[1,1]
    v_pk_mul_f32 v[134:135], v[134:135], v[4:5] op_sel:[0,1] op_sel_hi:[1,1]
    v_pk_fma_f32 v[136:137], v[128:129], s[84:85], v[136:137] op_sel:[0,0,0] op_sel_hi:[1,0,1]
    v_pk_fma_f32 v[138:139], v[130:131], s[84:85], v[138:139] op_sel:[0,0,0] op_sel_hi:[1,0,1]
    v_pk_fma_f32 v[140:141], v[132:133], s[84:85], v[140:141] op_sel:[0,1,0] op_sel_hi:[1,1,1]
    v_pk_fma_f32 v[142:143], v[134:135], s[84:85], v[142:143] op_sel:[0,1,0] op_sel_hi:[1,1,1]
    s_mul_i32 s4, s75, 8320
    s_lshl_b32 s5, s3, 10
    s_add_u32 s4, s4, s5
    s_add_u32 s5, s4, 0x541000
    s_mul_i32 s4, s3, 266240
    s_lshl_b32 s6, s75, 6
    s_add_u32 s4, s4, s6
    s_add_u32 s4, s4, 0x404000
    s_waitcnt lgkmcnt(0)
    s_barrier
    ds_read_b128 v[144:147], v248 offset:0
    ds_read_b128 v[148:151], v248 offset:5120
    ds_read_b128 v[152:155], v248 offset:10240
    ds_read_b128 v[156:159], v248 offset:15360
    s_waitcnt lgkmcnt(2)
    v_pk_add_f32 v[144:145], v[144:145], v[148:149]
    v_pk_add_f32 v[146:147], v[146:147], v[150:151]
    s_waitcnt lgkmcnt(0)
    v_pk_add_f32 v[152:153], v[152:153], v[156:157]
    v_pk_add_f32 v[154:155], v[154:155], v[158:159]
    v_pk_fma_f32 v[144:145], v[144:145], s[84:85], v[136:137] op_sel:[0,0,0] op_sel_hi:[1,0,1]
    v_pk_fma_f32 v[146:147], v[146:147], s[84:85], v[138:139] op_sel:[0,0,0] op_sel_hi:[1,0,1]
    v_pk_fma_f32 v[152:153], v[152:153], s[84:85], v[140:141] op_sel:[0,1,0] op_sel_hi:[1,1,1]
    v_pk_fma_f32 v[154:155], v[154:155], s[84:85], v[142:143] op_sel:[0,1,0] op_sel_hi:[1,1,1]
    v_cvt_pk_bf16_f32 v160, v144, v152
    v_cvt_pk_bf16_f32 v161, v145, v153
    v_cvt_pk_bf16_f32 v162, v146, v154
    v_cvt_pk_bf16_f32 v163, v147, v155
    v_lshlrev_b32_e64 v164, 16, v160
    v_and_b32 v165, 0xffff0000, v160
    v_lshlrev_b32_e64 v166, 16, v161
    v_and_b32 v167, 0xffff0000, v161
    v_lshlrev_b32_e64 v168, 16, v162
    v_and_b32 v169, 0xffff0000, v162
    v_lshlrev_b32_e64 v170, 16, v163
    v_and_b32 v171, 0xffff0000, v163
    v_pk_mul_f32 v[164:165], v[164:165], s[86:87]
    v_pk_mul_f32 v[166:167], v[166:167], s[86:87]
    v_pk_mul_f32 v[168:169], v[168:169], s[86:87]
    v_pk_mul_f32 v[170:171], v[170:171], s[86:87]
    v_cvt_pk_bf16_f32 v172, v164, v165
    v_cvt_pk_bf16_f32 v173, v166, v167
    v_cvt_pk_bf16_f32 v174, v168, v169
    v_cvt_pk_bf16_f32 v175, v170, v171
    buffer_store_dwordx4 v[172:175], v251, s[52:55], s5 offen sc1
    buffer_store_dwordx4 v[160:163], v59, s[52:55], s4 offen sc1
    s_waitcnt vmcnt(2)
L_xa_chk:
    s_nop 0
    v_min3_u32 v62, v200, v201, s72
    v_max3_u32 v63, v200, v201, s72
    v_min3_u32 v62, v202, v203, v62
    v_max3_u32 v63, v202, v203, v63
    v_min3_u32 v62, v33, v35, v62
    v_max3_u32 v63, v33, v35, v63
    v_cmp_ne_u32 vcc, v62, v63
    s_cbranch_vccz L_xa_ok
    s_sub_u32 s12, s12, 1
    s_cmp_lt_i32 s12, 0
    s_cbranch_scc1 L_xa_ok
    s_sleep 4
    buffer_load_dwordx4 v[200:203], v238, s[52:55], s36 offen sc1
    buffer_load_dwordx4 v[32:35], v252, s[52:55], s95 offen sc1
    s_waitcnt vmcnt(0)
    s_branch L_xa_chk
L_xa_ok:
    buffer_load_dwordx4 v[72:75], v8, s[52:55], s16 offen sc1
    buffer_load_dwordx4 v[76:79], v9, s[52:55], s16 offen sc1
    buffer_load_dwordx4 v[80:83], v8, s[52:55], s17 offen sc1
    buffer_load_dwordx4 v[84:87], v9, s[52:55], s17 offen sc1
    s_add_u32 s4, s60, 0x300000
    buffer_load_dwordx4 v[220:223], v234, s[52:55], s4 offen sc1
    buffer_load_dwordx4 v[88:91], v8, s[52:55], s18 offen sc1
    buffer_load_dwordx4 v[92:95], v9, s[52:55], s18 offen sc1
    buffer_load_dwordx4 v[96:99], v8, s[52:55], s19 offen sc1
    buffer_load_dwordx4 v[100:103], v9, s[52:55], s19 offen sc1
    v_lshrrev_b32_e64 v60, 1, v252
    v_add_u32 v60, 155648, v60
    ds_write2_b32 v60, v32, v34 offset0:0 offset1:1
    s_waitcnt lgkmcnt(0)
    s_barrier
    s_lshl_b32 s4, s3, 14
    v_add_u32 v60, s4, v10
    s_add_u32 s4, s3, 4
    s_min_u32 s4, s4, 6
    s_lshl_b32 s4, s4, 14
    v_add_u32 v61, s4, v10
    v_and_b32 v62, 1, v1
    v_lshlrev_b32 v63, 6, v62
    v_xor_b32 v62, 1, v62
    v_lshlrev_b32 v62, 10, v62
    v_and_b32_e64 v24, 48, v1
    s_mov_b32 s4, 155648
    v_add3_u32 v62, v62, v24, s4
    s_lshl_b32 s4, s3, 7
    s_nop 0
    s_add_u32 s4, s4, 157696
    v_add3_u32 v63, v63, v24, s4
    ds_read_b128 v[128:131], v62 offset:0
    ds_read_b128 v[132:135], v60 offset:0
    ds_read_b128 v[136:139], v61 offset:0
    ds_read_b128 v[140:143], v62 offset:64
    ds_read_b128 v[144:147], v60 offset:1024
    ds_read_b128 v[148:151], v61 offset:1024
    ds_read_b128 v[152:155], v62 offset:128
    ds_read_b128 v[156:159], v60 offset:2048
    ds_read_b128 v[160:163], v61 offset:2048
    ds_read_b128 v[164:167], v62 offset:192
    ds_read_b128 v[168:171], v60 offset:3072
    ds_read_b128 v[172:175], v61 offset:3072
    ds_read_b128 v[176:179], v62 offset:256
    ds_read_b128 v[180:183], v60 offset:4096
    ds_read_b128 v[184:187], v61 offset:4096
    s_waitcnt lgkmcnt(12)
    v_mfma_f32_16x16x32_bf16 v[16:19], v[132:135], v[128:131], 0
    v_mfma_f32_16x16x32_bf16 v[20:23], v[136:139], v[128:131], 0
    ds_read_b128 v[188:191], v62 offset:320
    ds_read_b128 v[192:195], v60 offset:5120
    ds_read_b128 v[196:199], v61 offset:5120
    s_waitcnt lgkmcnt(12)
    v_mfma_f32_16x16x32_bf16 v[16:19], v[144:147], v[140:143], v[16:19]
    v_mfma_f32_16x16x32_bf16 v[20:23], v[148:151], v[140:143], v[20:23]
    ds_read_b128 v[128:131], v62 offset:384
    ds_read_b128 v[132:135], v60 offset:6144
    ds_read_b128 v[136:139], v61 offset:6144
    s_waitcnt lgkmcnt(12)
    v_mfma_f32_16x16x32_bf16 v[16:19], v[156:159], v[152:155], v[16:19]
    v_mfma_f32_16x16x32_bf16 v[20:23], v[160:163], v[152:155], v[20:23]
    ds_read_b128 v[140:143], v62 offset:448
    ds_read_b128 v[144:147], v60 offset:7168
    ds_read_b128 v[148:151], v61 offset:7168
    s_waitcnt lgkmcnt(12)
    v_mfma_f32_16x16x32_bf16 v[16:19], v[168:171], v[164:167], v[16:19]
    v_mfma_f32_16x16x32_bf16 v[20:23], v[172:175], v[164:167], v[20:23]
    ds_read_b128 v[152:155], v62 offset:512
    ds_read_b128 v[156:159], v60 offset:8192
    ds_read_b128 v[160:163], v61 offset:8192
    s_waitcnt lgkmcnt(12)
    v_mfma_f32_16x16x32_bf16 v[16:19], v[180:183], v[176:179], v[16:19]
    v_mfma_f32_16x16x32_bf16 v[20:23], v[184:187], v[176:179], v[20:23]
    ds_read_b128 v[164:167], v62 offset:576
    ds_read_b128 v[168:171], v60 offset:9216
    ds_read_b128 v[172:175], v61 offset:9216
    s_waitcnt lgkmcnt(12)
    v_mfma_f32_16x16x32_bf16 v[16:19], v[192:195], v[188:191], v[16:19]
    v_mfma_f32_16x16x32_bf16 v[20:23], v[196:199], v[188:191], v[20:23]
    ds_read_b128 v[176:179], v62 offset:640
    ds_read_b128 v[180:183], v60 offset:10240
    ds_read_b128 v[184:187], v61 offset:10240
    s_waitcnt lgkmcnt(12)
    v_mfma_f32_16x16x32_bf16 v[16:19], v[132:135], v[128:131], v[16:19]
    v_mfma_f32_16x16x32_bf16 v[20:23], v[136:139], v[128:131], v[20:23]
    ds_read_b128 v[188:191], v62 offset:704
    ds_read_b128 v[192:195], v60 offset:11264
    ds_read_b128 v[196:199], v61 offset:11264
    s_waitcnt lgkmcnt(12)
    v_mfma_f32_16x16x32_bf16 v[16:19], v[144:147], v[140:143], v[16:19]
    v_mfma_f32_16x16x32_bf16 v[20:23], v[148:151], v[140:143], v[20:23]
    ds_read_b128 v[128:131], v62 offset:768
    ds_read_b128 v[132:135], v60 offset:12288
    ds_read_b128 v[136:139], v61 offset:12288
    s_waitcnt lgkmcnt(12)
    v_mfma_f32_16x16x32_bf16 v[16:19], v[156:159], v[152:155], v[16:19]
    v_mfma_f32_16x16x32_bf16 v[20:23], v[160:163], v[152:155], v[20:23]
    ds_read_b128 v[140:143], v62 offset:832
    ds_read_b128 v[144:147], v60 offset:13312
    ds_read_b128 v[148:151], v61 offset:13312
    s_waitcnt lgkmcnt(12)
    v_mfma_f32_16x16x32_bf16 v[16:19], v[168:171], v[164:167], v[16:19]
    v_mfma_f32_16x16x32_bf16 v[20:23], v[172:175], v[164:167], v[20:23]
    ds_read_b128 v[152:155], v62 offset:896
    ds_read_b128 v[156:159], v60 offset:14336
    ds_read_b128 v[160:163], v61 offset:14336
    s_waitcnt lgkmcnt(12)
    v_mfma_f32_16x16x32_bf16 v[16:19], v[180:183], v[176:179], v[16:19]
    v_mfma_f32_16x16x32_bf16 v[20:23], v[184:187], v[176:179], v[20:23]
    ds_read_b128 v[164:167], v62 offset:960
    ds_read_b128 v[168:171], v60 offset:15360
    ds_read_b128 v[172:175], v61 offset:15360
    s_waitcnt lgkmcnt(12)
    v_mfma_f32_16x16x32_bf16 v[16:19], v[192:195], v[188:191], v[16:19]
    v_mfma_f32_16x16x32_bf16 v[20:23], v[196:199], v[188:191], v[20:23]
    s_waitcnt lgkmcnt(9)
    v_mfma_f32_16x16x32_bf16 v[16:19], v[132:135], v[128:131], v[16:19]
    v_mfma_f32_16x16x32_bf16 v[20:23], v[136:139], v[128:131], v[20:23]
    s_waitcnt lgkmcnt(6)
    v_mfma_f32_16x16x32_bf16 v[16:19], v[144:147], v[140:143], v[16:19]
    v_mfma_f32_16x16x32_bf16 v[20:23], v[148:151], v[140:143], v[20:23]
    s_waitcnt lgkmcnt(3)
    v_mfma_f32_16x16x32_bf16 v[16:19], v[156:159], v[152:155], v[16:19]
    v_mfma_f32_16x16x32_bf16 v[20:23], v[160:163], v[152:155], v[20:23]
    s_waitcnt lgkmcnt(0)
    v_mfma_f32_16x16x32_bf16 v[16:19], v[168:171], v[164:167], v[16:19]
    v_mfma_f32_16x16x32_bf16 v[20:23], v[172:175], v[164:167], v[20:23]
    s_nop 6
    s_nop 0
    v_mul_f32 v16, 0xbfb8aa3b, v16
    v_mul_f32 v17, 0xbfb8aa3b, v17
    v_mul_f32 v20, 0xbfb8aa3b, v20
    v_mul_f32 v21, 0xbfb8aa3b, v21
    ds_write_b128 v63, v[16:19]
    ds_write_b128 v63, v[20:23] offset:512
    s_waitcnt vmcnt(9)
    s_barrier
    s_cmp_lg_u32 s3, 0
    s_cbranch_scc1 L_fxb
    v_mov_b32 v242, s72
    s_mov_b64 exec, 1
    buffer_store_dword v242, off, s[52:55], s39 sc1
    s_mov_b64 exec, -1
L_fxb:
    s_nop 0
    buffer_load_dwordx4 v[104:107], v8, s[52:55], s20 offen sc1
    buffer_load_dwordx4 v[108:111], v9, s[52:55], s20 offen sc1
    buffer_load_dwordx4 v[112:115], v8, s[52:55], s21 offen sc1
    buffer_load_dwordx4 v[116:119], v9, s[52:55], s21 offen sc1
    buffer_load_dwordx4 v[120:123], v8, s[52:55], s22 offen sc1
    buffer_load_dwordx4 v[124:127], v9, s[52:55], s22 offen sc1
    ds_read_b128 v[128:131], v10 offset:0
    ds_read_b128 v[132:135], v10 offset:16384
    ds_read_b128 v[136:139], v10 offset:32768
    ds_read_b128 v[140:143], v10 offset:49152
    ds_read_b128 v[144:147], v11 offset:0
    ds_read_b128 v[148:151], v11 offset:16384
    ds_read_b128 v[152:155], v11 offset:32768
    s_waitcnt vmcnt(10)
    s_nop 0
    s_mov_b32 s6, 0x3f803f80
    v_dot2_f32_bf16 v200, v220, s6, 0
    v_dot2_f32_bf16 v204, v220, v220, 0
    v_dot2_f32_bf16 v201, v221, s6, 0
    v_dot2_f32_bf16 v205, v221, v221, 0
    v_dot2_f32_bf16 v202, v222, s6, 0
    v_dot2_f32_bf16 v206, v222, v222, 0
    v_dot2_f32_bf16 v203, v223, s6, 0
    v_dot2_f32_bf16 v207, v223, v223, 0
    v_permlane32_swap_b32 v200, v204
    v_permlane32_swap_b32 v201, v205
    v_permlane32_swap_b32 v202, v206
    v_permlane32_swap_b32 v203, v207
    v_add_f32 v200, v200, v204
    v_add_f32 v201, v201, v205
    v_add_f32 v202, v202, v206
    v_add_f32 v203, v203, v207
    s_nop 0
    v_permlane16_swap_b32 v200, v202
    v_permlane16_swap_b32 v201, v203
    v_add_f32 v200, v200, v202
    v_add_f32 v201, v201, v203
    s_nop 0
    v_add_f32_dpp v200, v200, v200 row_ror:8 row_mask:0xf bank_mask:0xf
    v_add_f32_dpp v201, v201, v201 row_ror:8 row_mask:0xf bank_mask:0xf
    s_nop 0
    v_add_f32_dpp v200, v200, v200 row_ror:4 row_mask:0xf bank_mask:0xf
    v_add_f32_dpp v201, v201, v201 row_ror:4 row_mask:0xf bank_mask:0xf
    s_nop 0
    v_add_f32_dpp v200, v200, v200 row_ror:2 row_mask:0xf bank_mask:0xf
    v_add_f32_dpp v201, v201, v201 row_ror:2 row_mask:0xf bank_mask:0xf
    s_nop 0
    v_add_f32_dpp v200, v200, v200 row_ror:1 row_mask:0xf bank_mask:0xf
    v_add_f32_dpp v201, v201, v201 row_ror:1 row_mask:0xf bank_mask:0xf
    ds_write_b64 v235, v[200:201]
    s_mov_b64 vcc, s[42:43]
    v_cndmask_b32_dpp v184, v74, v72, vcc row_ror:8 row_mask:0xf bank_mask:0xf
    v_cndmask_b32_dpp v185, v78, v76, vcc row_ror:8 row_mask:0xf bank_mask:0xf
    v_cndmask_b32_dpp v188, v75, v73, vcc row_ror:8 row_mask:0xf bank_mask:0xf
    v_cndmask_b32_dpp v189, v79, v77, vcc row_ror:8 row_mask:0xf bank_mask:0xf
    s_mov_b64 vcc, s[44:45]
    v_cndmask_b32_dpp v186, v72, v74, vcc row_ror:8 row_mask:0xf bank_mask:0xf
    v_cndmask_b32_dpp v187, v76, v78, vcc row_ror:8 row_mask:0xf bank_mask:0xf
    v_cndmask_b32_dpp v190, v73, v75, vcc row_ror:8 row_mask:0xf bank_mask:0xf
    v_cndmask_b32_dpp v191, v77, v79, vcc row_ror:8 row_mask:0xf bank_mask:0xf
    s_waitcnt lgkmcnt(0)
    v_mfma_f32_16x16x32_bf16 v[16:19], v[128:131], v[184:187], 0
    ds_read_b128 v[156:159], v10 offset:1024
    ds_read_b128 v[160:163], v10 offset:17408
    v_mfma_f32_16x16x32_bf16 v[20:23], v[128:131], v[188:191], 0
    ds_read_b128 v[164:167], v10 offset:33792
    ds_read_b128 v[168:171], v10 offset:50176
    v_mfma_f32_16x16x32_bf16 v[24:27], v[132:135], v[184:187], 0
    ds_read_b128 v[172:175], v11 offset:1024
    ds_read_b128 v[176:179], v11 offset:17408
    v_mfma_f32_16x16x32_bf16 v[28:31], v[132:135], v[188:191], 0
    ds_read_b128 v[180:183], v11 offset:33792
    s_barrier
    v_mfma_f32_16x16x32_bf16 v[32:35], v[136:139], v[184:187], 0
    buffer_load_dwordx4 v[72:75], v8, s[52:55], s23 offen sc1
    v_mfma_f32_16x16x32_bf16 v[36:39], v[136:139], v[188:191], 0
    buffer_load_dwordx4 v[76:79], v9, s[52:55], s23 offen sc1
    v_mfma_f32_16x16x32_bf16 v[40:43], v[140:143], v[184:187], 0
    s_mov_b32 s63, 0x19000
    buffer_load_dwordx4 v[204:207], v238, s[52:55], s63 offen sc1
    v_mfma_f32_16x16x32_bf16 v[44:47], v[140:143], v[188:191], 0
    v_cndmask_b32_dpp v194, v80, v82, vcc row_ror:8 row_mask:0xf bank_mask:0xf
    v_mfma_f32_16x16x32_bf16 v[48:51], v[144:147], v[184:187], 0
    v_cndmask_b32_dpp v195, v84, v86, vcc row_ror:8 row_mask:0xf bank_mask:0xf
    v_cndmask_b32_dpp v198, v81, v83, vcc row_ror:8 row_mask:0xf bank_mask:0xf
    v_mfma_f32_16x16x32_bf16 v[52:55], v[144:147], v[188:191], 0
    v_cndmask_b32_dpp v199, v85, v87, vcc row_ror:8 row_mask:0xf bank_mask:0xf
    s_mov_b64 vcc, s[42:43]
    v_mfma_f32_16x16x32_bf16 v[56:59], v[148:151], v[184:187], 0
    ds_read2_b32 v[216:217], v236 offset0:0 offset1:4
    ds_read2_b32 v[218:219], v236 offset0:8 offset1:12
    v_mfma_f32_16x16x32_bf16 v[60:63], v[148:151], v[188:191], 0
    v_cndmask_b32_dpp v192, v82, v80, vcc row_ror:8 row_mask:0xf bank_mask:0xf
    v_cndmask_b32_dpp v193, v86, v84, vcc row_ror:8 row_mask:0xf bank_mask:0xf
    v_mfma_f32_16x16x32_bf16 v[64:67], v[152:155], v[184:187], 0
    v_cndmask_b32_dpp v196, v83, v81, vcc row_ror:8 row_mask:0xf bank_mask:0xf
    v_cndmask_b32_dpp v197, v87, v85, vcc row_ror:8 row_mask:0xf bank_mask:0xf
    v_mfma_f32_16x16x32_bf16 v[68:71], v[152:155], v[188:191], 0
    ds_read2_b32 v[220:221], v236 offset0:16 offset1:20
    ds_read2_b32 v[222:223], v236 offset0:24 offset1:28
    s_waitcnt lgkmcnt(0)
    v_mfma_f32_16x16x32_bf16 v[16:19], v[156:159], v[192:195], v[16:19]
    ds_read_b128 v[128:131], v10 offset:2048
    ds_read_b128 v[132:135], v10 offset:18432
    v_mfma_f32_16x16x32_bf16 v[20:23], v[156:159], v[196:199], v[20:23]
    ds_read_b128 v[136:139], v10 offset:34816
    ds_read_b128 v[140:143], v10 offset:51200
    v_mfma_f32_16x16x32_bf16 v[24:27], v[160:163], v[192:195], v[24:27]
    ds_read_b128 v[144:147], v11 offset:2048
    ds_read_b128 v[148:151], v11 offset:18432
    v_mfma_f32_16x16x32_bf16 v[28:31], v[160:163], v[196:199], v[28:31]
    ds_read_b128 v[152:155], v11 offset:34816
    v_add_f32 v216, v216, v218
    v_mfma_f32_16x16x32_bf16 v[32:35], v[164:167], v[192:195], v[32:35]
    buffer_load_dwordx4 v[80:83], v8, s[52:55], s24 offen sc1
    v_mfma_f32_16x16x32_bf16 v[36:39], v[164:167], v[196:199], v[36:39]
    buffer_load_dwordx4 v[84:87], v9, s[52:55], s24 offen sc1
    v_mfma_f32_16x16x32_bf16 v[40:43], v[168:171], v[192:195], v[40:43]
    v_add_f32_e64 v217, v217, v219
    v_mfma_f32_16x16x32_bf16 v[44:47], v[168:171], v[196:199], v[44:47]
    s_waitcnt vmcnt(13)
    v_cndmask_b32_dpp v184, v90, v88, vcc row_ror:8 row_mask:0xf bank_mask:0xf
    v_mfma_f32_16x16x32_bf16 v[48:51], v[172:175], v[192:195], v[48:51]
    v_cndmask_b32_dpp v185, v94, v92, vcc row_ror:8 row_mask:0xf bank_mask:0xf
    v_cndmask_b32_dpp v188, v91, v89, vcc row_ror:8 row_mask:0xf bank_mask:0xf
    v_mfma_f32_16x16x32_bf16 v[52:55], v[172:175], v[196:199], v[52:55]
    v_cndmask_b32_dpp v189, v95, v93, vcc row_ror:8 row_mask:0xf bank_mask:0xf
    s_mov_b64 vcc, s[44:45]
    v_mfma_f32_16x16x32_bf16 v[56:59], v[176:179], v[192:195], v[56:59]
    v_add_f32 v216, v216, v220
    v_add_f32 v217, v217, v221
    v_mfma_f32_16x16x32_bf16 v[60:63], v[176:179], v[196:199], v[60:63]
    v_cndmask_b32_dpp v186, v88, v90, vcc row_ror:8 row_mask:0xf bank_mask:0xf
    v_cndmask_b32_dpp v187, v92, v94, vcc row_ror:8 row_mask:0xf bank_mask:0xf
    v_mfma_f32_16x16x32_bf16 v[64:67], v[180:183], v[192:195], v[64:67]
    v_cndmask_b32_dpp v190, v89, v91, vcc row_ror:8 row_mask:0xf bank_mask:0xf
    v_cndmask_b32_dpp v191, v93, v95, vcc row_ror:8 row_mask:0xf bank_mask:0xf
    v_mfma_f32_16x16x32_bf16 v[68:71], v[180:183], v[196:199], v[68:71]
    v_add_f32 v216, v216, v222
    v_add_f32_e64 v217, v217, v223
    s_waitcnt lgkmcnt(0)
    v_mfma_f32_16x16x32_bf16 v[16:19], v[128:131], v[184:187], v[16:19]
    ds_read_b128 v[156:159], v10 offset:3072
    ds_read_b128 v[160:163], v10 offset:19456
    v_mfma_f32_16x16x32_bf16 v[20:23], v[128:131], v[188:191], v[20:23]
    ds_read_b128 v[164:167], v10 offset:35840
    ds_read_b128 v[168:171], v10 offset:52224
    v_mfma_f32_16x16x32_bf16 v[24:27], v[132:135], v[184:187], v[24:27]
    ds_read_b128 v[172:175], v11 offset:3072
    ds_read_b128 v[176:179], v11 offset:19456
    v_mfma_f32_16x16x32_bf16 v[28:31], v[132:135], v[188:191], v[28:31]
    ds_read_b128 v[180:183], v11 offset:35840
    v_mul_f32 v216, 0x3b000000, v216
    v_mfma_f32_16x16x32_bf16 v[32:35], v[136:139], v[184:187], v[32:35]
    buffer_load_dwordx4 v[88:91], v8, s[52:55], s25 offen sc1
    v_mfma_f32_16x16x32_bf16 v[36:39], v[136:139], v[188:191], v[36:39]
    buffer_load_dwordx4 v[92:95], v9, s[52:55], s25 offen sc1
    v_mfma_f32_16x16x32_bf16 v[40:43], v[140:143], v[184:187], v[40:43]
    v_mul_f32 v217, 0x3b000000, v217
    v_mfma_f32_16x16x32_bf16 v[44:47], v[140:143], v[188:191], v[44:47]
    s_waitcnt vmcnt(13)
    v_cndmask_b32_dpp v194, v96, v98, vcc row_ror:8 row_mask:0xf bank_mask:0xf
    v_mfma_f32_16x16x32_bf16 v[48:51], v[144:147], v[184:187], v[48:51]
    v_cndmask_b32_dpp v195, v100, v102, vcc row_ror:8 row_mask:0xf bank_mask:0xf
    v_cndmask_b32_dpp v198, v97, v99, vcc row_ror:8 row_mask:0xf bank_mask:0xf
    v_mfma_f32_16x16x32_bf16 v[52:55], v[144:147], v[188:191], v[52:55]
    v_cndmask_b32_dpp v199, v101, v103, vcc row_ror:8 row_mask:0xf bank_mask:0xf
    s_mov_b64 vcc, s[42:43]
    v_mfma_f32_16x16x32_bf16 v[56:59], v[148:151], v[184:187], v[56:59]
    v_fma_f32 v217, -v216, v216, v217
    v_max_f32_e64 v217, 0, v217
    v_mfma_f32_16x16x32_bf16 v[60:63], v[148:151], v[188:191], v[60:63]
    v_cndmask_b32_dpp v192, v98, v96, vcc row_ror:8 row_mask:0xf bank_mask:0xf
    v_cndmask_b32_dpp v193, v102, v100, vcc row_ror:8 row_mask:0xf bank_mask:0xf
    v_mfma_f32_16x16x32_bf16 v[64:67], v[152:155], v[184:187], v[64:67]
    v_cndmask_b32_dpp v196, v99, v97, vcc row_ror:8 row_mask:0xf bank_mask:0xf
    v_cndmask_b32_dpp v197, v103, v101, vcc row_ror:8 row_mask:0xf bank_mask:0xf
    v_mfma_f32_16x16x32_bf16 v[68:71], v[152:155], v[188:191], v[68:71]
    v_cvt_pk_bf16_f32 v218, v217, v217
    v_lshlrev_b32 v218, 16, v218
    s_waitcnt vmcnt(4)
L_r2_chk:
    v_min3_u32 v242, v204, v205, s72
    v_max3_u32 v243, v204, v205, s72
    v_min3_u32 v242, v206, v207, v242
    v_max3_u32 v243, v206, v207, v243
    v_cmp_ne_u32 vcc, v242, v243
    s_cbranch_vccz L_r2_ok
    s_sub_u32 s12, s12, 1
    s_cmp_lt_i32 s12, 0
    s_cbranch_scc1 L_r2_ok
    s_sleep 4
    buffer_load_dwordx4 v[204:207], v238, s[52:55], s63 offen sc1
    s_waitcnt vmcnt(0)
    s_branch L_r2_chk
L_r2_ok:
    s_mov_b64 vcc, s[42:43]
    s_waitcnt lgkmcnt(0)
    v_mfma_f32_16x16x32_bf16 v[16:19], v[156:159], v[192:195], v[16:19]
    ds_read_b128 v[128:131], v10 offset:4096
    ds_read_b128 v[132:135], v10 offset:20480
    v_mfma_f32_16x16x32_bf16 v[20:23], v[156:159], v[196:199], v[20:23]
    ds_read_b128 v[136:139], v10 offset:36864
    ds_read_b128 v[140:143], v10 offset:53248
    v_mfma_f32_16x16x32_bf16 v[24:27], v[160:163], v[192:195], v[24:27]
    ds_read_b128 v[144:147], v11 offset:4096
    ds_read_b128 v[148:151], v11 offset:20480
    v_mfma_f32_16x16x32_bf16 v[28:31], v[160:163], v[196:199], v[28:31]
    ds_read_b128 v[152:155], v11 offset:36864
    v_add_f32 v218, 0x3727c5ac, v218
    v_mfma_f32_16x16x32_bf16 v[32:35], v[164:167], v[192:195], v[32:35]
    buffer_load_dwordx4 v[96:99], v8, s[52:55], s26 offen sc1
    v_mfma_f32_16x16x32_bf16 v[36:39], v[164:167], v[196:199], v[36:39]
    buffer_load_dwordx4 v[100:103], v9, s[52:55], s26 offen sc1
    v_mfma_f32_16x16x32_bf16 v[40:43], v[168:171], v[192:195], v[40:43]
    v_cvt_pk_bf16_f32 v218, v218, v218
    buffer_load_dwordx4 a[0:3], v12, s[52:55], s32 offen offset:0 sc1
    v_mfma_f32_16x16x32_bf16 v[44:47], v[168:171], v[196:199], v[44:47]
    v_cndmask_b32_dpp v184, v106, v104, vcc row_ror:8 row_mask:0xf bank_mask:0xf
    v_mfma_f32_16x16x32_bf16 v[48:51], v[172:175], v[192:195], v[48:51]
    v_cndmask_b32_dpp v185, v110, v108, vcc row_ror:8 row_mask:0xf bank_mask:0xf
    v_cndmask_b32_dpp v188, v107, v105, vcc row_ror:8 row_mask:0xf bank_mask:0xf
    v_mfma_f32_16x16x32_bf16 v[52:55], v[172:175], v[196:199], v[52:55]
    v_cndmask_b32_dpp v189, v111, v109, vcc row_ror:8 row_mask:0xf bank_mask:0xf
    s_mov_b64 vcc, s[44:45]
    v_mfma_f32_16x16x32_bf16 v[56:59], v[176:179], v[192:195], v[56:59]
    v_lshlrev_b32 v218, 16, v218
    v_sqrt_f32_e64 v218, v218
    buffer_load_dwordx4 a[4:7], v13, s[52:55], s32 offen offset:0 sc1
    v_mfma_f32_16x16x32_bf16 v[60:63], v[176:179], v[196:199], v[60:63]
    v_cndmask_b32_dpp v186, v104, v106, vcc row_ror:8 row_mask:0xf bank_mask:0xf
    v_cndmask_b32_dpp v187, v108, v110, vcc row_ror:8 row_mask:0xf bank_mask:0xf
    v_mfma_f32_16x16x32_bf16 v[64:67], v[180:183], v[192:195], v[64:67]
    v_cndmask_b32_dpp v190, v105, v107, vcc row_ror:8 row_mask:0xf bank_mask:0xf
    v_cndmask_b32_dpp v191, v109, v111, vcc row_ror:8 row_mask:0xf bank_mask:0xf
    v_mfma_f32_16x16x32_bf16 v[68:71], v[180:183], v[196:199], v[68:71]
    v_cvt_pk_bf16_f32 v218, v218, v216
    v_mov_b32 v219, s72
    s_waitcnt lgkmcnt(0)
    v_mfma_f32_16x16x32_bf16 v[16:19], v[128:131], v[184:187], v[16:19]
    ds_read_b128 v[156:159], v10 offset:5120
    ds_read_b128 v[160:163], v10 offset:21504
    v_mfma_f32_16x16x32_bf16 v[20:23], v[128:131], v[188:191], v[20:23]
    ds_read_b128 v[164:167], v10 offset:37888
    ds_read_b128 v[168:171], v10 offset:54272
    v_mfma_f32_16x16x32_bf16 v[24:27], v[132:135], v[184:187], v[24:27]
    ds_read_b128 v[172:175], v11 offset:5120
    ds_read_b128 v[176:179], v11 offset:21504
    v_mfma_f32_16x16x32_bf16 v[28:31], v[132:135], v[188:191], v[28:31]
    ds_read_b128 v[180:183], v11 offset:37888
    v_add_u32_e64 v244, s59, v8
    v_mfma_f32_16x16x32_bf16 v[32:35], v[136:139], v[184:187], v[32:35]
    buffer_load_dwordx4 v[104:107], v8, s[52:55], s27 offen sc1
    v_mfma_f32_16x16x32_bf16 v[36:39], v[136:139], v[188:191], v[36:39]
    buffer_load_dwordx4 v[108:111], v9, s[52:55], s27 offen sc1
    v_mfma_f32_16x16x32_bf16 v[40:43], v[140:143], v[184:187], v[40:43]
    buffer_load_dwordx4 a[8:11], v14, s[52:55], s32 offen offset:0 sc1
    v_mfma_f32_16x16x32_bf16 v[44:47], v[140:143], v[188:191], v[44:47]
    v_cndmask_b32_dpp v194, v112, v114, vcc row_ror:8 row_mask:0xf bank_mask:0xf
    v_add_u32_e64 v245, s59, v9
    v_mfma_f32_16x16x32_bf16 v[48:51], v[144:147], v[184:187], v[48:51]
    v_cndmask_b32_dpp v195, v116, v118, vcc row_ror:8 row_mask:0xf bank_mask:0xf
    v_cndmask_b32_dpp v198, v113, v115, vcc row_ror:8 row_mask:0xf bank_mask:0xf
    v_mfma_f32_16x16x32_bf16 v[52:55], v[144:147], v[188:191], v[52:55]
    v_cndmask_b32_dpp v199, v117, v119, vcc row_ror:8 row_mask:0xf bank_mask:0xf
    s_mov_b64 vcc, s[42:43]
    v_mfma_f32_16x16x32_bf16 v[56:59], v[148:151], v[184:187], v[56:59]
    v_and_b32 v246, 1, v1
    v_lshrrev_b32_e64 v247, 5, v1
    buffer_load_dwordx4 a[12:15], v15, s[52:55], s32 offen offset:0 sc1
    v_mfma_f32_16x16x32_bf16 v[60:63], v[148:151], v[188:191], v[60:63]
    v_cndmask_b32_dpp v192, v114, v112, vcc row_ror:8 row_mask:0xf bank_mask:0xf
    v_cndmask_b32_dpp v193, v118, v116, vcc row_ror:8 row_mask:0xf bank_mask:0xf
    v_mfma_f32_16x16x32_bf16 v[64:67], v[152:155], v[184:187], v[64:67]
    v_cndmask_b32_dpp v196, v115, v113, vcc row_ror:8 row_mask:0xf bank_mask:0xf
    v_cndmask_b32_dpp v197, v119, v117, vcc row_ror:8 row_mask:0xf bank_mask:0xf
    v_mfma_f32_16x16x32_bf16 v[68:71], v[152:155], v[188:191], v[68:71]
    v_lshl_add_u32 v6, v247, 1, v246
    v_bfe_u32 v246, v1, 1, 3
    s_lshl_b32 s4, s92, 1
    s_add_u32 s4, s4, 0x5000
    s_mov_b64 exec, 15
    buffer_store_dwordx2 v[218:219], v237, s[52:55], s4 offen sc1
    s_mov_b64 exec, -1
    s_waitcnt lgkmcnt(0)
    v_mfma_f32_16x16x32_bf16 v[16:19], v[156:159], v[192:195], v[16:19]
    ds_read_b128 v[128:131], v10 offset:6144
    ds_read_b128 v[132:135], v10 offset:22528
    v_mfma_f32_16x16x32_bf16 v[20:23], v[156:159], v[196:199], v[20:23]
    ds_read_b128 v[136:139], v10 offset:38912
    ds_read_b128 v[140:143], v10 offset:55296
    v_mfma_f32_16x16x32_bf16 v[24:27], v[160:163], v[192:195], v[24:27]
    ds_read_b128 v[144:147], v11 offset:6144
    ds_read_b128 v[148:151], v11 offset:22528
    v_mfma_f32_16x16x32_bf16 v[28:31], v[160:163], v[196:199], v[28:31]
    ds_read_b128 v[152:155], v11 offset:38912
    v_bfe_u32 v247, v1, 4, 1
    v_mfma_f32_16x16x32_bf16 v[32:35], v[164:167], v[192:195], v[32:35]
    buffer_load_dwordx4 v[112:115], v8, s[52:55], s28 offen sc1
    v_mfma_f32_16x16x32_bf16 v[36:39], v[164:167], v[196:199], v[36:39]
    buffer_load_dwordx4 v[116:119], v9, s[52:55], s28 offen sc1
    v_mfma_f32_16x16x32_bf16 v[40:43], v[168:171], v[192:195], v[40:43]
    buffer_load_dwordx4 a[16:19], v12, s[52:55], s32 offen offset:1024 sc1
    v_mfma_f32_16x16x32_bf16 v[44:47], v[168:171], v[196:199], v[44:47]
    v_cndmask_b32_dpp v184, v122, v120, vcc row_ror:8 row_mask:0xf bank_mask:0xf
    v_lshl_add_u32 v246, v246, 1, v247
    v_mfma_f32_16x16x32_bf16 v[48:51], v[172:175], v[192:195], v[48:51]
    v_cndmask_b32_dpp v185, v126, v124, vcc row_ror:8 row_mask:0xf bank_mask:0xf
    v_cndmask_b32_dpp v188, v123, v121, vcc row_ror:8 row_mask:0xf bank_mask:0xf
    v_mfma_f32_16x16x32_bf16 v[52:55], v[172:175], v[196:199], v[52:55]
    v_cndmask_b32_dpp v189, v127, v125, vcc row_ror:8 row_mask:0xf bank_mask:0xf
    s_mov_b64 vcc, s[44:45]
    v_mfma_f32_16x16x32_bf16 v[56:59], v[176:179], v[192:195], v[56:59]
    v_lshrrev_b32 v5, 3, v246
    v_mul_u32_u24 v5, 16576, v5
    buffer_load_dwordx4 a[20:23], v13, s[52:55], s32 offen offset:1024 sc1
    v_mfma_f32_16x16x32_bf16 v[60:63], v[176:179], v[196:199], v[60:63]
    v_cndmask_b32_dpp v186, v120, v122, vcc row_ror:8 row_mask:0xf bank_mask:0xf
    v_cndmask_b32_dpp v187, v124, v126, vcc row_ror:8 row_mask:0xf bank_mask:0xf
    v_mfma_f32_16x16x32_bf16 v[64:67], v[180:183], v[192:195], v[64:67]
    v_cndmask_b32_dpp v190, v121, v123, vcc row_ror:8 row_mask:0xf bank_mask:0xf
    v_cndmask_b32_dpp v191, v125, v127, vcc row_ror:8 row_mask:0xf bank_mask:0xf
    v_mfma_f32_16x16x32_bf16 v[68:71], v[180:183], v[196:199], v[68:71]
    v_lshl_add_u32 v5, v246, 3, v5
    v_lshl_add_u32 v5, v6, 8, v5
    s_waitcnt lgkmcnt(0)
    v_mfma_f32_16x16x32_bf16 v[16:19], v[128:131], v[184:187], v[16:19]
    ds_read_b128 v[156:159], v10 offset:7168
    ds_read_b128 v[160:163], v10 offset:23552
    v_mfma_f32_16x16x32_bf16 v[20:23], v[128:131], v[188:191], v[20:23]
    ds_read_b128 v[164:167], v10 offset:39936
    ds_read_b128 v[168:171], v10 offset:56320
    v_mfma_f32_16x16x32_bf16 v[24:27], v[132:135], v[184:187], v[24:27]
    ds_read_b128 v[172:175], v11 offset:7168
    ds_read_b128 v[176:179], v11 offset:23552
    v_mfma_f32_16x16x32_bf16 v[28:31], v[132:135], v[188:191], v[28:31]
    ds_read_b128 v[180:183], v11 offset:39936
    v_lshlrev_b32 v2, 11, v246
    v_mfma_f32_16x16x32_bf16 v[32:35], v[136:139], v[184:187], v[32:35]
    buffer_load_dwordx4 v[120:123], v8, s[52:55], s29 offen sc1
    v_mfma_f32_16x16x32_bf16 v[36:39], v[136:139], v[188:191], v[36:39]
    buffer_load_dwordx4 v[124:127], v9, s[52:55], s29 offen sc1
    v_mfma_f32_16x16x32_bf16 v[40:43], v[140:143], v[184:187], v[40:43]
    buffer_load_dwordx4 a[24:27], v14, s[52:55], s32 offen offset:1024 sc1
    v_mfma_f32_16x16x32_bf16 v[44:47], v[140:143], v[188:191], v[44:47]
    v_cndmask_b32_dpp v194, v72, v74, vcc row_ror:8 row_mask:0xf bank_mask:0xf
    v_lshl_add_u32 v2, v6, 4, v2
    v_mfma_f32_16x16x32_bf16 v[48:51], v[144:147], v[184:187], v[48:51]
    v_cndmask_b32_dpp v195, v76, v78, vcc row_ror:8 row_mask:0xf bank_mask:0xf
    v_cndmask_b32_dpp v198, v73, v75, vcc row_ror:8 row_mask:0xf bank_mask:0xf
    v_mfma_f32_16x16x32_bf16 v[52:55], v[144:147], v[188:191], v[52:55]
    v_cndmask_b32_dpp v199, v77, v79, vcc row_ror:8 row_mask:0xf bank_mask:0xf
    s_mov_b64 vcc, s[42:43]
    v_mfma_f32_16x16x32_bf16 v[56:59], v[148:151], v[184:187], v[56:59]
    v_lshlrev_b32_e64 v6, 5, v6
    s_lshr_b32 s14, s3, 1
    buffer_load_dwordx4 a[28:31], v15, s[52:55], s32 offen offset:1024 sc1
    v_mfma_f32_16x16x32_bf16 v[60:63], v[148:151], v[188:191], v[60:63]
    v_cndmask_b32_dpp v192, v74, v72, vcc row_ror:8 row_mask:0xf bank_mask:0xf
    v_cndmask_b32_dpp v193, v78, v76, vcc row_ror:8 row_mask:0xf bank_mask:0xf
    v_mfma_f32_16x16x32_bf16 v[64:67], v[152:155], v[184:187], v[64:67]
    v_cndmask_b32_dpp v196, v75, v73, vcc row_ror:8 row_mask:0xf bank_mask:0xf
    v_cndmask_b32_dpp v197, v79, v77, vcc row_ror:8 row_mask:0xf bank_mask:0xf
    v_mfma_f32_16x16x32_bf16 v[68:71], v[152:155], v[188:191], v[68:71]
    s_and_b32 s15, s3, 1
    s_lshl_b32 s46, s90, 8
    s_waitcnt lgkmcnt(0)
    v_mfma_f32_16x16x32_bf16 v[16:19], v[156:159], v[192:195], v[16:19]
    ds_read_b128 v[128:131], v10 offset:8192
    ds_read_b128 v[132:135], v10 offset:24576
    v_mfma_f32_16x16x32_bf16 v[20:23], v[156:159], v[196:199], v[20:23]
    ds_read_b128 v[136:139], v10 offset:40960
    ds_read_b128 v[140:143], v10 offset:57344
    v_mfma_f32_16x16x32_bf16 v[24:27], v[160:163], v[192:195], v[24:27]
    ds_read_b128 v[144:147], v11 offset:8192
    ds_read_b128 v[148:151], v11 offset:24576
    v_mfma_f32_16x16x32_bf16 v[28:31], v[160:163], v[196:199], v[28:31]
    ds_read_b128 v[152:155], v11 offset:40960
    s_lshl_b32 s9, s14, 7
    v_mfma_f32_16x16x32_bf16 v[32:35], v[164:167], v[192:195], v[32:35]
    buffer_load_dwordx4 v[72:75], v8, s[52:55], s30 offen sc1
    v_mfma_f32_16x16x32_bf16 v[36:39], v[164:167], v[196:199], v[36:39]
    buffer_load_dwordx4 v[76:79], v9, s[52:55], s30 offen sc1
    v_mfma_f32_16x16x32_bf16 v[40:43], v[168:171], v[192:195], v[40:43]
    buffer_load_dwordx4 a[32:35], v12, s[52:55], s32 offen offset:2048 sc1
    v_mfma_f32_16x16x32_bf16 v[44:47], v[168:171], v[196:199], v[44:47]
    s_waitcnt vmcnt(22)
    v_cndmask_b32_dpp v184, v82, v80, vcc row_ror:8 row_mask:0xf bank_mask:0xf
    s_add_u32 s46, s46, s9
    v_mfma_f32_16x16x32_bf16 v[48:51], v[172:175], v[192:195], v[48:51]
    v_cndmask_b32_dpp v185, v86, v84, vcc row_ror:8 row_mask:0xf bank_mask:0xf
    v_cndmask_b32_dpp v188, v83, v81, vcc row_ror:8 row_mask:0xf bank_mask:0xf
    v_mfma_f32_16x16x32_bf16 v[52:55], v[172:175], v[196:199], v[52:55]
    v_cndmask_b32_dpp v189, v87, v85, vcc row_ror:8 row_mask:0xf bank_mask:0xf
    s_mov_b64 vcc, s[44:45]
    v_mfma_f32_16x16x32_bf16 v[56:59], v[176:179], v[192:195], v[56:59]
    s_add_u32 s46, s46, 0xa000
    s_lshl_b32 s47, s90, 11
    buffer_load_dwordx4 a[36:39], v13, s[52:55], s32 offen offset:2048 sc1
    v_mfma_f32_16x16x32_bf16 v[60:63], v[176:179], v[196:199], v[60:63]
    v_cndmask_b32_dpp v186, v80, v82, vcc row_ror:8 row_mask:0xf bank_mask:0xf
    v_cndmask_b32_dpp v187, v84, v86, vcc row_ror:8 row_mask:0xf bank_mask:0xf
    v_mfma_f32_16x16x32_bf16 v[64:67], v[180:183], v[192:195], v[64:67]
    v_cndmask_b32_dpp v190, v81, v83, vcc row_ror:8 row_mask:0xf bank_mask:0xf
    v_cndmask_b32_dpp v191, v85, v87, vcc row_ror:8 row_mask:0xf bank_mask:0xf
    v_mfma_f32_16x16x32_bf16 v[68:71], v[180:183], v[196:199], v[68:71]
    s_lshl_b32 s9, s14, 10
    s_add_u32 s47, s47, s9
    s_waitcnt lgkmcnt(0)
    v_mfma_f32_16x16x32_bf16 v[16:19], v[128:131], v[184:187], v[16:19]
    ds_read_b128 v[156:159], v10 offset:9216
    ds_read_b128 v[160:163], v10 offset:25600
    v_mfma_f32_16x16x32_bf16 v[20:23], v[128:131], v[188:191], v[20:23]
    ds_read_b128 v[164:167], v10 offset:41984
    ds_read_b128 v[168:171], v10 offset:58368
    v_mfma_f32_16x16x32_bf16 v[24:27], v[132:135], v[184:187], v[24:27]
    ds_read_b128 v[172:175], v11 offset:9216
    ds_read_b128 v[176:179], v11 offset:25600
    v_mfma_f32_16x16x32_bf16 v[28:31], v[132:135], v[188:191], v[28:31]
    ds_read_b128 v[180:183], v11 offset:41984
    s_mul_i32 s9, s89, 33280
    v_mfma_f32_16x16x32_bf16 v[32:35], v[136:139], v[184:187], v[32:35]
    buffer_load_dwordx4 v[80:83], v8, s[52:55], s31 offen sc1
    v_mfma_f32_16x16x32_bf16 v[36:39], v[136:139], v[188:191], v[36:39]
    buffer_load_dwordx4 v[84:87], v9, s[52:55], s31 offen sc1
    v_mfma_f32_16x16x32_bf16 v[40:43], v[140:143], v[184:187], v[40:43]
    buffer_load_dwordx4 a[40:43], v14, s[52:55], s32 offen offset:2048 sc1
    v_mfma_f32_16x16x32_bf16 v[44:47], v[140:143], v[188:191], v[44:47]
    s_waitcnt vmcnt(24)
    v_cndmask_b32_dpp v194, v88, v90, vcc row_ror:8 row_mask:0xf bank_mask:0xf
    s_add_u32 s47, s47, s9
    v_mfma_f32_16x16x32_bf16 v[48:51], v[144:147], v[184:187], v[48:51]
    v_cndmask_b32_dpp v195, v92, v94, vcc row_ror:8 row_mask:0xf bank_mask:0xf
    v_cndmask_b32_dpp v198, v89, v91, vcc row_ror:8 row_mask:0xf bank_mask:0xf
    v_mfma_f32_16x16x32_bf16 v[52:55], v[144:147], v[188:191], v[52:55]
    v_cndmask_b32_dpp v199, v93, v95, vcc row_ror:8 row_mask:0xf bank_mask:0xf
    s_mov_b64 vcc, s[42:43]
    v_mfma_f32_16x16x32_bf16 v[56:59], v[148:151], v[184:187], v[56:59]
    s_lshl_b32 s9, s15, 2
    s_add_u32 s47, s47, s9
    buffer_load_dwordx4 a[44:47], v15, s[52:55], s32 offen offset:2048 sc1
    v_mfma_f32_16x16x32_bf16 v[60:63], v[148:151], v[188:191], v[60:63]
    v_cndmask_b32_dpp v192, v90, v88, vcc row_ror:8 row_mask:0xf bank_mask:0xf
    v_cndmask_b32_dpp v193, v94, v92, vcc row_ror:8 row_mask:0xf bank_mask:0xf
    v_mfma_f32_16x16x32_bf16 v[64:67], v[152:155], v[184:187], v[64:67]
    v_cndmask_b32_dpp v196, v91, v89, vcc row_ror:8 row_mask:0xf bank_mask:0xf
    v_cndmask_b32_dpp v197, v95, v93, vcc row_ror:8 row_mask:0xf bank_mask:0xf
    v_mfma_f32_16x16x32_bf16 v[68:71], v[152:155], v[188:191], v[68:71]
    s_add_u32 s47, s47, 0x300000
    s_lshl_b32 s41, s89, 15
    s_waitcnt lgkmcnt(0)
    v_mfma_f32_16x16x32_bf16 v[16:19], v[156:159], v[192:195], v[16:19]
    ds_read_b128 v[128:131], v10 offset:10240
    ds_read_b128 v[132:135], v10 offset:26624
    v_mfma_f32_16x16x32_bf16 v[20:23], v[156:159], v[196:199], v[20:23]
    ds_read_b128 v[136:139], v10 offset:43008
    ds_read_b128 v[140:143], v10 offset:59392
    v_mfma_f32_16x16x32_bf16 v[24:27], v[160:163], v[192:195], v[24:27]
    ds_read_b128 v[144:147], v11 offset:10240
    ds_read_b128 v[148:151], v11 offset:26624
    v_mfma_f32_16x16x32_bf16 v[28:31], v[160:163], v[196:199], v[28:31]
    ds_read_b128 v[152:155], v11 offset:43008
    s_lshl_b32 s9, s15, 10
    v_mfma_f32_16x16x32_bf16 v[32:35], v[164:167], v[192:195], v[32:35]
    buffer_load_dwordx4 a[48:51], v12, s[52:55], s32 offen offset:3072 sc1
    v_mfma_f32_16x16x32_bf16 v[36:39], v[164:167], v[196:199], v[36:39]
    buffer_load_dwordx4 a[52:55], v13, s[52:55], s32 offen offset:3072 sc1
    v_mfma_f32_16x16x32_bf16 v[40:43], v[168:171], v[192:195], v[40:43]
    buffer_load_dwordx4 a[56:59], v14, s[52:55], s32 offen offset:3072 sc1
    v_mfma_f32_16x16x32_bf16 v[44:47], v[168:171], v[196:199], v[44:47]
    s_waitcnt vmcnt(26)
    v_cndmask_b32_dpp v184, v98, v96, vcc row_ror:8 row_mask:0xf bank_mask:0xf
    s_add_u32 s41, s41, s9
    v_mfma_f32_16x16x32_bf16 v[48:51], v[172:175], v[192:195], v[48:51]
    v_cndmask_b32_dpp v185, v102, v100, vcc row_ror:8 row_mask:0xf bank_mask:0xf
    v_cndmask_b32_dpp v188, v99, v97, vcc row_ror:8 row_mask:0xf bank_mask:0xf
    v_mfma_f32_16x16x32_bf16 v[52:55], v[172:175], v[196:199], v[52:55]
    v_cndmask_b32_dpp v189, v103, v101, vcc row_ror:8 row_mask:0xf bank_mask:0xf
    s_mov_b64 vcc, s[44:45]
    v_mfma_f32_16x16x32_bf16 v[56:59], v[176:179], v[192:195], v[56:59]
    s_lshl_b32 s9, s90, 7
    s_add_u32 s41, s41, s9
    buffer_load_dwordx4 a[60:63], v15, s[52:55], s32 offen offset:3072 sc1
    v_mfma_f32_16x16x32_bf16 v[60:63], v[176:179], v[196:199], v[60:63]
    v_cndmask_b32_dpp v186, v96, v98, vcc row_ror:8 row_mask:0xf bank_mask:0xf
    v_cndmask_b32_dpp v187, v100, v102, vcc row_ror:8 row_mask:0xf bank_mask:0xf
    v_mfma_f32_16x16x32_bf16 v[64:67], v[180:183], v[192:195], v[64:67]
    v_cndmask_b32_dpp v190, v97, v99, vcc row_ror:8 row_mask:0xf bank_mask:0xf
    v_cndmask_b32_dpp v191, v101, v103, vcc row_ror:8 row_mask:0xf bank_mask:0xf
    v_mfma_f32_16x16x32_bf16 v[68:71], v[180:183], v[196:199], v[68:71]
    s_lshl_b32 s9, s14, 6
    s_add_u32 s41, s41, s9
    v_add_u32 v8, 0x1000, v8
    v_add_u32 v9, 0x1000, v9
    s_waitcnt lgkmcnt(0)
    v_mfma_f32_16x16x32_bf16 v[16:19], v[128:131], v[184:187], v[16:19]
    ds_read_b128 v[156:159], v10 offset:11264
    ds_read_b128 v[160:163], v10 offset:27648
    v_mfma_f32_16x16x32_bf16 v[20:23], v[128:131], v[188:191], v[20:23]
    ds_read_b128 v[164:167], v10 offset:44032
    ds_read_b128 v[168:171], v10 offset:60416
    v_mfma_f32_16x16x32_bf16 v[24:27], v[132:135], v[184:187], v[24:27]
    ds_read_b128 v[172:175], v11 offset:11264
    ds_read_b128 v[176:179], v11 offset:27648
    v_mfma_f32_16x16x32_bf16 v[28:31], v[132:135], v[188:191], v[28:31]
    ds_read_b128 v[180:183], v11 offset:44032
    s_lshl_b32 s8, s3, 12
    v_mfma_f32_16x16x32_bf16 v[32:35], v[136:139], v[184:187], v[32:35]
    buffer_load_dwordx4 v[200:203], v238, s[52:55], s37 offen sc1
    v_mfma_f32_16x16x32_bf16 v[36:39], v[136:139], v[188:191], v[36:39]
    buffer_load_dwordx4 a[64:67], v12, s[52:55], s33 offen offset:0 sc1
    v_mfma_f32_16x16x32_bf16 v[40:43], v[140:143], v[184:187], v[40:43]
    buffer_load_dwordx4 a[68:71], v13, s[52:55], s33 offen offset:0 sc1
    v_mfma_f32_16x16x32_bf16 v[44:47], v[140:143], v[188:191], v[44:47]
    s_waitcnt vmcnt(26)
    v_cndmask_b32_dpp v194, v104, v106, vcc row_ror:8 row_mask:0xf bank_mask:0xf
    v_lshl_add_u32 v3, v1, 4, s8
    v_mfma_f32_16x16x32_bf16 v[48:51], v[144:147], v[184:187], v[48:51]
    v_cndmask_b32_dpp v195, v108, v110, vcc row_ror:8 row_mask:0xf bank_mask:0xf
    v_cndmask_b32_dpp v198, v105, v107, vcc row_ror:8 row_mask:0xf bank_mask:0xf
    v_mfma_f32_16x16x32_bf16 v[52:55], v[144:147], v[188:191], v[52:55]
    v_cndmask_b32_dpp v199, v109, v111, vcc row_ror:8 row_mask:0xf bank_mask:0xf
    s_mov_b64 vcc, s[42:43]
    v_mfma_f32_16x16x32_bf16 v[56:59], v[148:151], v[184:187], v[56:59]
    s_lshl_b32 s8, s15, 14
    s_lshl_b32 s9, s14, 9
    buffer_load_dwordx4 a[72:75], v14, s[52:55], s33 offen offset:0 sc1
    v_mfma_f32_16x16x32_bf16 v[60:63], v[148:151], v[188:191], v[60:63]
    v_cndmask_b32_dpp v192, v106, v104, vcc row_ror:8 row_mask:0xf bank_mask:0xf
    v_cndmask_b32_dpp v193, v110, v108, vcc row_ror:8 row_mask:0xf bank_mask:0xf
    v_mfma_f32_16x16x32_bf16 v[64:67], v[152:155], v[184:187], v[64:67]
    v_cndmask_b32_dpp v196, v107, v105, vcc row_ror:8 row_mask:0xf bank_mask:0xf
    v_cndmask_b32_dpp v197, v111, v109, vcc row_ror:8 row_mask:0xf bank_mask:0xf
    v_mfma_f32_16x16x32_bf16 v[68:71], v[152:155], v[188:191], v[68:71]
    s_add_u32 s8, s8, s9
    v_lshl_add_u32 v4, v1, 3, s8
    buffer_load_dwordx4 a[76:79], v15, s[52:55], s33 offen offset:0 sc1
    s_waitcnt lgkmcnt(0)
    v_mfma_f32_16x16x32_bf16 v[16:19], v[156:159], v[192:195], v[16:19]
    ds_read_b128 v[128:131], v10 offset:12288
    ds_read_b128 v[132:135], v10 offset:28672
    v_mfma_f32_16x16x32_bf16 v[20:23], v[156:159], v[196:199], v[20:23]
    ds_read_b128 v[136:139], v10 offset:45056
    ds_read_b128 v[140:143], v10 offset:61440
    v_mfma_f32_16x16x32_bf16 v[24:27], v[160:163], v[192:195], v[24:27]
    ds_read_b128 v[144:147], v11 offset:12288
    ds_read_b128 v[148:151], v11 offset:28672
    v_mfma_f32_16x16x32_bf16 v[28:31], v[160:163], v[196:199], v[28:31]
    ds_read_b128 v[152:155], v11 offset:45056
    v_mfma_f32_16x16x32_bf16 v[32:35], v[164:167], v[192:195], v[32:35]
    buffer_load_dwordx4 a[80:83], v12, s[52:55], s33 offen offset:1024 sc1
    v_mfma_f32_16x16x32_bf16 v[36:39], v[164:167], v[196:199], v[36:39]
    buffer_load_dwordx4 a[84:87], v13, s[52:55], s33 offen offset:1024 sc1
    v_mfma_f32_16x16x32_bf16 v[40:43], v[168:171], v[192:195], v[40:43]
    buffer_load_dwordx4 a[88:91], v14, s[52:55], s33 offen offset:1024 sc1
    v_mfma_f32_16x16x32_bf16 v[44:47], v[168:171], v[196:199], v[44:47]
    s_waitcnt vmcnt(26)
    v_cndmask_b32_dpp v184, v114, v112, vcc row_ror:8 row_mask:0xf bank_mask:0xf
    v_mfma_f32_16x16x32_bf16 v[48:51], v[172:175], v[192:195], v[48:51]
    v_cndmask_b32_dpp v185, v118, v116, vcc row_ror:8 row_mask:0xf bank_mask:0xf
    v_cndmask_b32_dpp v188, v115, v113, vcc row_ror:8 row_mask:0xf bank_mask:0xf
    v_mfma_f32_16x16x32_bf16 v[52:55], v[172:175], v[196:199], v[52:55]
    v_cndmask_b32_dpp v189, v119, v117, vcc row_ror:8 row_mask:0xf bank_mask:0xf
    s_mov_b64 vcc, s[44:45]
    v_mfma_f32_16x16x32_bf16 v[56:59], v[176:179], v[192:195], v[56:59]
    buffer_load_dwordx4 a[92:95], v15, s[52:55], s33 offen offset:1024 sc1
    v_mfma_f32_16x16x32_bf16 v[60:63], v[176:179], v[196:199], v[60:63]
    v_cndmask_b32_dpp v186, v112, v114, vcc row_ror:8 row_mask:0xf bank_mask:0xf
    v_cndmask_b32_dpp v187, v116, v118, vcc row_ror:8 row_mask:0xf bank_mask:0xf
    v_mfma_f32_16x16x32_bf16 v[64:67], v[180:183], v[192:195], v[64:67]
    v_cndmask_b32_dpp v190, v113, v115, vcc row_ror:8 row_mask:0xf bank_mask:0xf
    v_cndmask_b32_dpp v191, v117, v119, vcc row_ror:8 row_mask:0xf bank_mask:0xf
    v_mfma_f32_16x16x32_bf16 v[68:71], v[180:183], v[196:199], v[68:71]
    s_waitcnt lgkmcnt(0)
    v_mfma_f32_16x16x32_bf16 v[16:19], v[128:131], v[184:187], v[16:19]
    ds_read_b128 v[156:159], v10 offset:13312
    ds_read_b128 v[160:163], v10 offset:29696
    v_mfma_f32_16x16x32_bf16 v[20:23], v[128:131], v[188:191], v[20:23]
    ds_read_b128 v[164:167], v10 offset:46080
    ds_read_b128 v[168:171], v10 offset:62464
    v_mfma_f32_16x16x32_bf16 v[24:27], v[132:135], v[184:187], v[24:27]
    ds_read_b128 v[172:175], v11 offset:13312
    ds_read_b128 v[176:179], v11 offset:29696
    v_mfma_f32_16x16x32_bf16 v[28:31], v[132:135], v[188:191], v[28:31]
    ds_read_b128 v[180:183], v11 offset:46080
    v_mfma_f32_16x16x32_bf16 v[32:35], v[136:139], v[184:187], v[32:35]
    buffer_load_dwordx4 v[228:231], v239, s[52:55], s94 offen sc1
    v_mfma_f32_16x16x32_bf16 v[36:39], v[136:139], v[188:191], v[36:39]
    buffer_load_dwordx4 a[96:99], v12, s[52:55], s33 offen offset:2048 sc1
    v_mfma_f32_16x16x32_bf16 v[40:43], v[140:143], v[184:187], v[40:43]
    buffer_load_dwordx4 a[100:103], v13, s[52:55], s33 offen offset:2048 sc1
    v_mfma_f32_16x16x32_bf16 v[44:47], v[140:143], v[188:191], v[44:47]
    s_waitcnt vmcnt(26)
    v_cndmask_b32_dpp v194, v120, v122, vcc row_ror:8 row_mask:0xf bank_mask:0xf
    v_mfma_f32_16x16x32_bf16 v[48:51], v[144:147], v[184:187], v[48:51]
    v_cndmask_b32_dpp v195, v124, v126, vcc row_ror:8 row_mask:0xf bank_mask:0xf
    v_cndmask_b32_dpp v198, v121, v123, vcc row_ror:8 row_mask:0xf bank_mask:0xf
    v_mfma_f32_16x16x32_bf16 v[52:55], v[144:147], v[188:191], v[52:55]
    v_cndmask_b32_dpp v199, v125, v127, vcc row_ror:8 row_mask:0xf bank_mask:0xf
    s_mov_b64 vcc, s[42:43]
    v_mfma_f32_16x16x32_bf16 v[56:59], v[148:151], v[184:187], v[56:59]
    buffer_load_dwordx4 a[104:107], v14, s[52:55], s33 offen offset:2048 sc1
    v_mfma_f32_16x16x32_bf16 v[60:63], v[148:151], v[188:191], v[60:63]
    v_cndmask_b32_dpp v192, v122, v120, vcc row_ror:8 row_mask:0xf bank_mask:0xf
    v_cndmask_b32_dpp v193, v126, v124, vcc row_ror:8 row_mask:0xf bank_mask:0xf
    v_mfma_f32_16x16x32_bf16 v[64:67], v[152:155], v[184:187], v[64:67]
    v_cndmask_b32_dpp v196, v123, v121, vcc row_ror:8 row_mask:0xf bank_mask:0xf
    v_cndmask_b32_dpp v197, v127, v125, vcc row_ror:8 row_mask:0xf bank_mask:0xf
    v_mfma_f32_16x16x32_bf16 v[68:71], v[152:155], v[188:191], v[68:71]
    buffer_load_dwordx4 a[108:111], v15, s[52:55], s33 offen offset:2048 sc1
    s_waitcnt vmcnt(13)
L_xb_chk:
    v_min3_u32 v242, v200, v201, s72
    v_max3_u32 v243, v200, v201, s72
    v_min3_u32 v242, v202, v203, v242
    v_max3_u32 v243, v202, v203, v243
    v_cmp_ne_u32 vcc, v242, v243
    s_cbranch_vccz L_xb_ok
    s_sub_u32 s12, s12, 1
    s_cmp_lt_i32 s12, 0
    s_cbranch_scc1 L_xb_ok
    s_sleep 4
    buffer_load_dwordx4 v[200:203], v238, s[52:55], s37 offen sc1
    s_waitcnt vmcnt(0)
    s_branch L_xb_chk
L_xb_ok:
    s_mov_b64 vcc, s[42:43]
    s_waitcnt lgkmcnt(0)
    v_mfma_f32_16x16x32_bf16 v[16:19], v[156:159], v[192:195], v[16:19]
    ds_read_b128 v[128:131], v10 offset:14336
    ds_read_b128 v[132:135], v10 offset:30720
    v_mfma_f32_16x16x32_bf16 v[20:23], v[156:159], v[196:199], v[20:23]
    ds_read_b128 v[136:139], v10 offset:47104
    ds_read_b128 v[140:143], v10 offset:63488
    v_mfma_f32_16x16x32_bf16 v[24:27], v[160:163], v[192:195], v[24:27]
    ds_read_b128 v[144:147], v11 offset:14336
    ds_read_b128 v[148:151], v11 offset:30720
    v_mfma_f32_16x16x32_bf16 v[28:31], v[160:163], v[196:199], v[28:31]
    ds_read_b128 v[152:155], v11 offset:47104
    v_mfma_f32_16x16x32_bf16 v[32:35], v[164:167], v[192:195], v[32:35]
    buffer_load_dwordx4 v[88:91], v8, s[52:55], s16 offen sc1
    v_mfma_f32_16x16x32_bf16 v[36:39], v[164:167], v[196:199], v[36:39]
    buffer_load_dwordx4 v[92:95], v9, s[52:55], s16 offen sc1
    v_mfma_f32_16x16x32_bf16 v[40:43], v[168:171], v[192:195], v[40:43]
    buffer_load_dwordx4 v[96:99], v8, s[52:55], s17 offen sc1
    v_mfma_f32_16x16x32_bf16 v[44:47], v[168:171], v[196:199], v[44:47]
    v_cndmask_b32_dpp v184, v74, v72, vcc row_ror:8 row_mask:0xf bank_mask:0xf
    v_mfma_f32_16x16x32_bf16 v[48:51], v[172:175], v[192:195], v[48:51]
    v_cndmask_b32_dpp v185, v78, v76, vcc row_ror:8 row_mask:0xf bank_mask:0xf
    v_cndmask_b32_dpp v188, v75, v73, vcc row_ror:8 row_mask:0xf bank_mask:0xf
    v_mfma_f32_16x16x32_bf16 v[52:55], v[172:175], v[196:199], v[52:55]
    v_cndmask_b32_dpp v189, v79, v77, vcc row_ror:8 row_mask:0xf bank_mask:0xf
    s_mov_b64 vcc, s[44:45]
    v_mfma_f32_16x16x32_bf16 v[56:59], v[176:179], v[192:195], v[56:59]
    buffer_load_dwordx4 v[100:103], v9, s[52:55], s17 offen sc1
    v_mfma_f32_16x16x32_bf16 v[60:63], v[176:179], v[196:199], v[60:63]
    v_cndmask_b32_dpp v186, v72, v74, vcc row_ror:8 row_mask:0xf bank_mask:0xf
    v_cndmask_b32_dpp v187, v76, v78, vcc row_ror:8 row_mask:0xf bank_mask:0xf
    v_mfma_f32_16x16x32_bf16 v[64:67], v[180:183], v[192:195], v[64:67]
    v_cndmask_b32_dpp v190, v73, v75, vcc row_ror:8 row_mask:0xf bank_mask:0xf
    v_cndmask_b32_dpp v191, v77, v79, vcc row_ror:8 row_mask:0xf bank_mask:0xf
    v_mfma_f32_16x16x32_bf16 v[68:71], v[180:183], v[196:199], v[68:71]
    s_waitcnt lgkmcnt(0)
    v_mfma_f32_16x16x32_bf16 v[16:19], v[128:131], v[184:187], v[16:19]
    ds_read_b128 v[156:159], v10 offset:15360
    ds_read_b128 v[160:163], v10 offset:31744
    v_mfma_f32_16x16x32_bf16 v[20:23], v[128:131], v[188:191], v[20:23]
    ds_read_b128 v[164:167], v10 offset:48128
    ds_read_b128 v[168:171], v10 offset:64512
    v_mfma_f32_16x16x32_bf16 v[24:27], v[132:135], v[184:187], v[24:27]
    ds_read_b128 v[172:175], v11 offset:15360
    ds_read_b128 v[176:179], v11 offset:31744
    v_mfma_f32_16x16x32_bf16 v[28:31], v[132:135], v[188:191], v[28:31]
    ds_read_b128 v[180:183], v11 offset:48128
    v_mfma_f32_16x16x32_bf16 v[32:35], v[136:139], v[184:187], v[32:35]
    buffer_load_dwordx4 v[104:107], v8, s[52:55], s18 offen sc1
    v_mfma_f32_16x16x32_bf16 v[36:39], v[136:139], v[188:191], v[36:39]
    buffer_load_dwordx4 v[108:111], v9, s[52:55], s18 offen sc1
    v_mfma_f32_16x16x32_bf16 v[40:43], v[140:143], v[184:187], v[40:43]
    buffer_load_dwordx4 v[112:115], v8, s[52:55], s19 offen sc1
    v_mfma_f32_16x16x32_bf16 v[44:47], v[140:143], v[188:191], v[44:47]
    v_cndmask_b32_dpp v194, v80, v82, vcc row_ror:8 row_mask:0xf bank_mask:0xf
    v_mfma_f32_16x16x32_bf16 v[48:51], v[144:147], v[184:187], v[48:51]
    v_cndmask_b32_dpp v195, v84, v86, vcc row_ror:8 row_mask:0xf bank_mask:0xf
    v_cndmask_b32_dpp v198, v81, v83, vcc row_ror:8 row_mask:0xf bank_mask:0xf
    v_mfma_f32_16x16x32_bf16 v[52:55], v[144:147], v[188:191], v[52:55]
    v_cndmask_b32_dpp v199, v85, v87, vcc row_ror:8 row_mask:0xf bank_mask:0xf
    s_mov_b64 vcc, s[42:43]
    v_mfma_f32_16x16x32_bf16 v[56:59], v[148:151], v[184:187], v[56:59]
    buffer_load_dwordx4 v[116:119], v9, s[52:55], s19 offen sc1
    v_mfma_f32_16x16x32_bf16 v[60:63], v[148:151], v[188:191], v[60:63]
    v_cndmask_b32_dpp v192, v82, v80, vcc row_ror:8 row_mask:0xf bank_mask:0xf
    v_cndmask_b32_dpp v193, v86, v84, vcc row_ror:8 row_mask:0xf bank_mask:0xf
    v_mfma_f32_16x16x32_bf16 v[64:67], v[152:155], v[184:187], v[64:67]
    v_cndmask_b32_dpp v196, v83, v81, vcc row_ror:8 row_mask:0xf bank_mask:0xf
    v_cndmask_b32_dpp v197, v87, v85, vcc row_ror:8 row_mask:0xf bank_mask:0xf
    v_mfma_f32_16x16x32_bf16 v[68:71], v[152:155], v[188:191], v[68:71]
    s_waitcnt lgkmcnt(0)
    v_mfma_f32_16x16x32_bf16 v[16:19], v[156:159], v[192:195], v[16:19]
    ds_read_b128 v[128:131], v233 offset:0
    v_mfma_f32_16x16x32_bf16 v[20:23], v[156:159], v[196:199], v[20:23]
    ds_read_b128 v[132:135], v233 offset:64
    v_mfma_f32_16x16x32_bf16 v[24:27], v[160:163], v[192:195], v[24:27]
    ds_read_b128 v[136:139], v233 offset:128
    v_mfma_f32_16x16x32_bf16 v[28:31], v[160:163], v[196:199], v[28:31]
    ds_read_b128 v[140:143], v233 offset:192
    v_mfma_f32_16x16x32_bf16 v[32:35], v[164:167], v[192:195], v[32:35]
    ds_read_b128 v[144:147], v233 offset:256
    buffer_load_dwordx4 v[120:123], v8, s[52:55], s20 offen sc1
    v_mfma_f32_16x16x32_bf16 v[36:39], v[164:167], v[196:199], v[36:39]
    ds_read_b128 v[148:151], v233 offset:320
    buffer_load_dwordx4 v[124:127], v9, s[52:55], s20 offen sc1
    v_mfma_f32_16x16x32_bf16 v[40:43], v[168:171], v[192:195], v[40:43]
    buffer_load_dwordx4 v[72:75], v8, s[52:55], s21 offen sc1
    v_mfma_f32_16x16x32_bf16 v[44:47], v[168:171], v[196:199], v[44:47]
    v_mfma_f32_16x16x32_bf16 v[48:51], v[172:175], v[192:195], v[48:51]
    v_mfma_f32_16x16x32_bf16 v[52:55], v[172:175], v[196:199], v[52:55]
    v_mfma_f32_16x16x32_bf16 v[56:59], v[176:179], v[192:195], v[56:59]
    buffer_load_dwordx4 v[76:79], v9, s[52:55], s21 offen sc1
    v_mfma_f32_16x16x32_bf16 v[60:63], v[176:179], v[196:199], v[60:63]
    v_mfma_f32_16x16x32_bf16 v[64:67], v[180:183], v[192:195], v[64:67]
    v_mfma_f32_16x16x32_bf16 v[68:71], v[180:183], v[196:199], v[68:71]
    buffer_load_dwordx4 v[80:83], v8, s[52:55], s22 offen sc1
    buffer_load_dwordx4 v[84:87], v9, s[52:55], s22 offen sc1
    s_add_u32 s4, s60, 0x404000
    buffer_load_dwordx4 v[220:223], v234, s[52:55], s4 offen sc1
    s_waitcnt vmcnt(19)
L_s20_chk:
    v_min3_u32 v242, v229, v231, s72
    v_max3_u32 v243, v229, v231, s72
    v_cmp_ne_u32 vcc, v242, v243
    s_cbranch_vccz L_s20_ok
    s_sub_u32 s12, s12, 1
    s_cmp_lt_i32 s12, 0
    s_cbranch_scc1 L_s20_ok
    s_sleep 4
    buffer_load_dwordx4 v[228:231], v239, s[52:55], s94 offen sc1
    s_waitcnt vmcnt(0)
    s_branch L_s20_chk
L_s20_ok:
    v_lshlrev_b32 v184, 16, v228
    v_and_b32 v186, 0xffff0000, v228
    v_lshlrev_b32_e64 v188, 16, v230
    v_and_b32 v190, 0xffff0000, v230
    v_rcp_f32 v184, v184
    v_rcp_f32 v188, v188
    ds_read_b128 v[152:155], v233 offset:384
    ds_read_b128 v[156:159], v233 offset:448
    ds_read_b128 v[160:163], v233 offset:512
    ds_read_b128 v[164:167], v233 offset:576
    ds_read_b128 v[168:171], v233 offset:640
    ds_read_b128 v[172:175], v233 offset:704
    ds_read_b128 v[176:179], v233 offset:768
    ds_read_b128 v[180:183], v233 offset:832
    s_mul_i32 s6, s77, 232960
    s_add_u32 s6, s6, s79
    s_add_u32 s6, s6, 0xd00000
    v_mul_f32 v185, 0xbfb8aa3b, v184
    v_mul_f32 v186, -v186, v184
    v_mul_f32 v189, 0xbfb8aa3b, v188
    v_mul_f32 v190, -v190, v188
    s_waitcnt lgkmcnt(8)
    v_pk_fma_f32 v[200:201], v[128:129], v[186:187], v[132:133] op_sel:[0,0,0] op_sel_hi:[1,0,1]
    v_pk_fma_f32 v[204:205], v[128:129], v[190:191], v[132:133] op_sel:[0,0,0] op_sel_hi:[1,0,1]
    v_pk_fma_f32 v[208:209], v[136:137], v[186:187], v[140:141] op_sel:[0,0,0] op_sel_hi:[1,0,1]
    v_pk_fma_f32 v[212:213], v[136:137], v[190:191], v[140:141] op_sel:[0,0,0] op_sel_hi:[1,0,1]
    v_pk_fma_f32 v[202:203], v[130:131], v[186:187], v[134:135] op_sel:[0,0,0] op_sel_hi:[1,0,1]
    v_pk_fma_f32 v[206:207], v[130:131], v[190:191], v[134:135] op_sel:[0,0,0] op_sel_hi:[1,0,1]
    v_pk_fma_f32 v[210:211], v[138:139], v[186:187], v[142:143] op_sel:[0,0,0] op_sel_hi:[1,0,1]
    v_pk_fma_f32 v[214:215], v[138:139], v[190:191], v[142:143] op_sel:[0,0,0] op_sel_hi:[1,0,1]
    v_pk_fma_f32 v[200:201], v[16:17], v[184:185], v[200:201] op_sel:[0,1,0] op_sel_hi:[1,1,1]
    v_pk_fma_f32 v[204:205], v[20:21], v[188:189], v[204:205] op_sel:[0,1,0] op_sel_hi:[1,1,1]
    v_pk_fma_f32 v[208:209], v[24:25], v[184:185], v[208:209] op_sel:[0,1,0] op_sel_hi:[1,1,1]
    v_pk_fma_f32 v[212:213], v[28:29], v[188:189], v[212:213] op_sel:[0,1,0] op_sel_hi:[1,1,1]
    v_exp_f32 v200, v200
    v_exp_f32 v201, v201
    v_exp_f32 v204, v204
    v_exp_f32 v205, v205
    v_exp_f32 v208, v208
    v_exp_f32 v209, v209
    v_exp_f32 v212, v212
    v_exp_f32 v213, v213
    v_pk_fma_f32 v[202:203], v[18:19], v[184:185], v[202:203] op_sel:[0,0,0] op_sel_hi:[1,0,1]
    v_pk_fma_f32 v[206:207], v[22:23], v[188:189], v[206:207] op_sel:[0,0,0] op_sel_hi:[1,0,1]
    v_pk_fma_f32 v[210:211], v[26:27], v[184:185], v[210:211] op_sel:[0,0,0] op_sel_hi:[1,0,1]
    v_pk_fma_f32 v[214:215], v[30:31], v[188:189], v[214:215] op_sel:[0,0,0] op_sel_hi:[1,0,1]
    v_pk_add_f32 v[200:201], v[200:201], 1.0 op_sel_hi:[1,0]
    v_pk_add_f32 v[204:205], v[204:205], 1.0 op_sel_hi:[1,0]
    v_pk_add_f32 v[208:209], v[208:209], 1.0 op_sel_hi:[1,0]
    v_pk_add_f32 v[212:213], v[212:213], 1.0 op_sel_hi:[1,0]
    v_rcp_f32 v200, v200
    v_rcp_f32 v201, v201
    v_rcp_f32 v204, v204
    v_rcp_f32 v205, v205
    v_rcp_f32 v208, v208
    v_rcp_f32 v209, v209
    v_rcp_f32 v212, v212
    v_rcp_f32 v213, v213
    v_pk_mul_f32 v[200:201], v[200:201], v[202:203]
    v_pk_mul_f32 v[204:205], v[204:205], v[206:207]
    v_pk_mul_f32 v[208:209], v[208:209], v[210:211]
    v_pk_mul_f32 v[212:213], v[212:213], v[214:215]
    v_cvt_pk_bf16_f32 v224, v200, v201
    v_cvt_pk_bf16_f32 v225, v204, v205
    v_cvt_pk_bf16_f32 v226, v208, v209
    v_cvt_pk_bf16_f32 v227, v212, v213
    buffer_store_dwordx2 v[224:225], v232, s[52:55], s6 offen sc1
    s_add_u32 s6, s6, 33280
    buffer_store_dwordx2 v[226:227], v232, s[52:55], s6 offen sc1
    s_add_u32 s6, s6, 33280
    s_waitcnt lgkmcnt(6)
    s_nop 0
    v_pk_fma_f32 v[200:201], v[144:145], v[186:187], v[148:149] op_sel:[0,0,0] op_sel_hi:[1,0,1]
    v_pk_fma_f32 v[204:205], v[144:145], v[190:191], v[148:149] op_sel:[0,0,0] op_sel_hi:[1,0,1]
    v_pk_fma_f32 v[208:209], v[152:153], v[186:187], v[156:157] op_sel:[0,0,0] op_sel_hi:[1,0,1]
    v_pk_fma_f32 v[212:213], v[152:153], v[190:191], v[156:157] op_sel:[0,0,0] op_sel_hi:[1,0,1]
    v_pk_fma_f32 v[202:203], v[146:147], v[186:187], v[150:151] op_sel:[0,0,0] op_sel_hi:[1,0,1]
    v_pk_fma_f32 v[206:207], v[146:147], v[190:191], v[150:151] op_sel:[0,0,0] op_sel_hi:[1,0,1]
    v_pk_fma_f32 v[210:211], v[154:155], v[186:187], v[158:159] op_sel:[0,0,0] op_sel_hi:[1,0,1]
    v_pk_fma_f32 v[214:215], v[154:155], v[190:191], v[158:159] op_sel:[0,0,0] op_sel_hi:[1,0,1]
    v_pk_fma_f32 v[200:201], v[32:33], v[184:185], v[200:201] op_sel:[0,1,0] op_sel_hi:[1,1,1]
    v_pk_fma_f32 v[204:205], v[36:37], v[188:189], v[204:205] op_sel:[0,1,0] op_sel_hi:[1,1,1]
    v_pk_fma_f32 v[208:209], v[40:41], v[184:185], v[208:209] op_sel:[0,1,0] op_sel_hi:[1,1,1]
    v_pk_fma_f32 v[212:213], v[44:45], v[188:189], v[212:213] op_sel:[0,1,0] op_sel_hi:[1,1,1]
    v_exp_f32 v200, v200
    v_exp_f32 v201, v201
    v_exp_f32 v204, v204
    v_exp_f32 v205, v205
    v_exp_f32 v208, v208
    v_exp_f32 v209, v209
    v_exp_f32 v212, v212
    v_exp_f32 v213, v213
    v_pk_fma_f32 v[202:203], v[34:35], v[184:185], v[202:203] op_sel:[0,0,0] op_sel_hi:[1,0,1]
    v_pk_fma_f32 v[206:207], v[38:39], v[188:189], v[206:207] op_sel:[0,0,0] op_sel_hi:[1,0,1]
    v_pk_fma_f32 v[210:211], v[42:43], v[184:185], v[210:211] op_sel:[0,0,0] op_sel_hi:[1,0,1]
    v_pk_fma_f32 v[214:215], v[46:47], v[188:189], v[214:215] op_sel:[0,0,0] op_sel_hi:[1,0,1]
    v_pk_add_f32 v[200:201], v[200:201], 1.0 op_sel_hi:[1,0]
    v_pk_add_f32 v[204:205], v[204:205], 1.0 op_sel_hi:[1,0]
    v_pk_add_f32 v[208:209], v[208:209], 1.0 op_sel_hi:[1,0]
    v_pk_add_f32 v[212:213], v[212:213], 1.0 op_sel_hi:[1,0]
    v_rcp_f32 v200, v200
    v_rcp_f32 v201, v201
    v_rcp_f32 v204, v204
    v_rcp_f32 v205, v205
    v_rcp_f32 v208, v208
    v_rcp_f32 v209, v209
    v_rcp_f32 v212, v212
    v_rcp_f32 v213, v213
    v_pk_mul_f32 v[200:201], v[200:201], v[202:203]
    v_pk_mul_f32 v[204:205], v[204:205], v[206:207]
    v_pk_mul_f32 v[208:209], v[208:209], v[210:211]
    v_pk_mul_f32 v[212:213], v[212:213], v[214:215]
    v_cvt_pk_bf16_f32 v224, v200, v201
    v_cvt_pk_bf16_f32 v225, v204, v205
    v_cvt_pk_bf16_f32 v226, v208, v209
    v_cvt_pk_bf16_f32 v227, v212, v213
    buffer_store_dwordx2 v[224:225], v232, s[52:55], s6 offen sc1
    s_add_u32 s6, s6, 33280
    buffer_store_dwordx2 v[226:227], v232, s[52:55], s6 offen sc1
    s_add_u32 s6, s6, 33280
    s_waitcnt lgkmcnt(2)
    s_nop 0
    v_pk_fma_f32 v[200:201], v[160:161], v[186:187], v[164:165] op_sel:[0,0,0] op_sel_hi:[1,0,1]
    v_pk_fma_f32 v[204:205], v[160:161], v[190:191], v[164:165] op_sel:[0,0,0] op_sel_hi:[1,0,1]
    v_pk_fma_f32 v[208:209], v[168:169], v[186:187], v[172:173] op_sel:[0,0,0] op_sel_hi:[1,0,1]
    v_pk_fma_f32 v[212:213], v[168:169], v[190:191], v[172:173] op_sel:[0,0,0] op_sel_hi:[1,0,1]
    v_pk_fma_f32 v[202:203], v[162:163], v[186:187], v[166:167] op_sel:[0,0,0] op_sel_hi:[1,0,1]
    v_pk_fma_f32 v[206:207], v[162:163], v[190:191], v[166:167] op_sel:[0,0,0] op_sel_hi:[1,0,1]
    v_pk_fma_f32 v[210:211], v[170:171], v[186:187], v[174:175] op_sel:[0,0,0] op_sel_hi:[1,0,1]
    v_pk_fma_f32 v[214:215], v[170:171], v[190:191], v[174:175] op_sel:[0,0,0] op_sel_hi:[1,0,1]
    v_pk_fma_f32 v[200:201], v[48:49], v[184:185], v[200:201] op_sel:[0,1,0] op_sel_hi:[1,1,1]
    v_pk_fma_f32 v[204:205], v[52:53], v[188:189], v[204:205] op_sel:[0,1,0] op_sel_hi:[1,1,1]
    v_pk_fma_f32 v[208:209], v[56:57], v[184:185], v[208:209] op_sel:[0,1,0] op_sel_hi:[1,1,1]
    v_pk_fma_f32 v[212:213], v[60:61], v[188:189], v[212:213] op_sel:[0,1,0] op_sel_hi:[1,1,1]
    v_exp_f32 v200, v200
    v_exp_f32 v201, v201
    v_exp_f32 v204, v204
    v_exp_f32 v205, v205
    v_exp_f32 v208, v208
    v_exp_f32 v209, v209
    v_exp_f32 v212, v212
    v_exp_f32 v213, v213
    v_pk_fma_f32 v[202:203], v[50:51], v[184:185], v[202:203] op_sel:[0,0,0] op_sel_hi:[1,0,1]
    v_pk_fma_f32 v[206:207], v[54:55], v[188:189], v[206:207] op_sel:[0,0,0] op_sel_hi:[1,0,1]
    v_pk_fma_f32 v[210:211], v[58:59], v[184:185], v[210:211] op_sel:[0,0,0] op_sel_hi:[1,0,1]
    v_pk_fma_f32 v[214:215], v[62:63], v[188:189], v[214:215] op_sel:[0,0,0] op_sel_hi:[1,0,1]
    v_pk_add_f32 v[200:201], v[200:201], 1.0 op_sel_hi:[1,0]
    v_pk_add_f32 v[204:205], v[204:205], 1.0 op_sel_hi:[1,0]
    v_pk_add_f32 v[208:209], v[208:209], 1.0 op_sel_hi:[1,0]
    v_pk_add_f32 v[212:213], v[212:213], 1.0 op_sel_hi:[1,0]
    v_rcp_f32 v200, v200
    v_rcp_f32 v201, v201
    v_rcp_f32 v204, v204
    v_rcp_f32 v205, v205
    v_rcp_f32 v208, v208
    v_rcp_f32 v209, v209
    v_rcp_f32 v212, v212
    v_rcp_f32 v213, v213
    v_pk_mul_f32 v[200:201], v[200:201], v[202:203]
    v_pk_mul_f32 v[204:205], v[204:205], v[206:207]
    v_pk_mul_f32 v[208:209], v[208:209], v[210:211]
    v_pk_mul_f32 v[212:213], v[212:213], v[214:215]
    v_cvt_pk_bf16_f32 v224, v200, v201
    v_cvt_pk_bf16_f32 v225, v204, v205
    v_cvt_pk_bf16_f32 v226, v208, v209
    v_cvt_pk_bf16_f32 v227, v212, v213
    buffer_store_dwordx2 v[224:225], v232, s[52:55], s6 offen sc1
    s_add_u32 s6, s6, 33280
    buffer_store_dwordx2 v[226:227], v232, s[52:55], s6 offen sc1
    s_add_u32 s6, s6, 33280
    s_waitcnt lgkmcnt(0)
    s_nop 0
    v_pk_fma_f32 v[200:201], v[176:177], v[186:187], v[180:181] op_sel:[0,0,0] op_sel_hi:[1,0,1]
    v_pk_fma_f32 v[204:205], v[176:177], v[190:191], v[180:181] op_sel:[0,0,0] op_sel_hi:[1,0,1]
    v_pk_fma_f32 v[202:203], v[178:179], v[186:187], v[182:183] op_sel:[0,0,0] op_sel_hi:[1,0,1]
    v_pk_fma_f32 v[206:207], v[178:179], v[190:191], v[182:183] op_sel:[0,0,0] op_sel_hi:[1,0,1]
    v_pk_fma_f32 v[200:201], v[64:65], v[184:185], v[200:201] op_sel:[0,1,0] op_sel_hi:[1,1,1]
    v_pk_fma_f32 v[204:205], v[68:69], v[188:189], v[204:205] op_sel:[0,1,0] op_sel_hi:[1,1,1]
    v_exp_f32 v200, v200
    v_exp_f32 v201, v201
    v_exp_f32 v204, v204
    v_exp_f32 v205, v205
    v_pk_fma_f32 v[202:203], v[66:67], v[184:185], v[202:203] op_sel:[0,0,0] op_sel_hi:[1,0,1]
    v_pk_fma_f32 v[206:207], v[70:71], v[188:189], v[206:207] op_sel:[0,0,0] op_sel_hi:[1,0,1]
    v_pk_add_f32 v[200:201], v[200:201], 1.0 op_sel_hi:[1,0]
    v_pk_add_f32 v[204:205], v[204:205], 1.0 op_sel_hi:[1,0]
    v_rcp_f32 v200, v200
    v_rcp_f32 v201, v201
    v_rcp_f32 v204, v204
    v_rcp_f32 v205, v205
    v_pk_mul_f32 v[200:201], v[200:201], v[202:203]
    v_pk_mul_f32 v[204:205], v[204:205], v[206:207]
    v_cvt_pk_bf16_f32 v224, v200, v201
    v_cvt_pk_bf16_f32 v225, v204, v205
    buffer_store_dwordx2 v[224:225], v232, s[52:55], s6 offen sc1
    ds_read_b128 v[128:131], v10 offset:0
    ds_read_b128 v[132:135], v10 offset:16384
    ds_read_b128 v[136:139], v10 offset:32768
    ds_read_b128 v[140:143], v10 offset:49152
    ds_read_b128 v[144:147], v11 offset:0
    ds_read_b128 v[148:151], v11 offset:16384
    ds_read_b128 v[152:155], v11 offset:32768
    s_waitcnt vmcnt(7)
    s_nop 0
    s_mov_b32 s6, 0x3f803f80
    v_dot2_f32_bf16 v200, v220, s6, 0
    v_dot2_f32_bf16 v204, v220, v220, 0
    v_dot2_f32_bf16 v201, v221, s6, 0
    v_dot2_f32_bf16 v205, v221, v221, 0
    v_dot2_f32_bf16 v202, v222, s6, 0
    v_dot2_f32_bf16 v206, v222, v222, 0
    v_dot2_f32_bf16 v203, v223, s6, 0
    v_dot2_f32_bf16 v207, v223, v223, 0
    v_permlane32_swap_b32 v200, v204
    v_permlane32_swap_b32 v201, v205
    v_permlane32_swap_b32 v202, v206
    v_permlane32_swap_b32 v203, v207
    v_add_f32 v200, v200, v204
    v_add_f32 v201, v201, v205
    v_add_f32 v202, v202, v206
    v_add_f32 v203, v203, v207
    s_nop 0
    v_permlane16_swap_b32 v200, v202
    v_permlane16_swap_b32 v201, v203
    v_add_f32 v200, v200, v202
    v_add_f32 v201, v201, v203
    s_nop 0
    v_add_f32_dpp v200, v200, v200 row_ror:8 row_mask:0xf bank_mask:0xf
    v_add_f32_dpp v201, v201, v201 row_ror:8 row_mask:0xf bank_mask:0xf
    s_nop 0
    v_add_f32_dpp v200, v200, v200 row_ror:4 row_mask:0xf bank_mask:0xf
    v_add_f32_dpp v201, v201, v201 row_ror:4 row_mask:0xf bank_mask:0xf
    s_nop 0
    v_add_f32_dpp v200, v200, v200 row_ror:2 row_mask:0xf bank_mask:0xf
    v_add_f32_dpp v201, v201, v201 row_ror:2 row_mask:0xf bank_mask:0xf
    s_nop 0
    v_add_f32_dpp v200, v200, v200 row_ror:1 row_mask:0xf bank_mask:0xf
    v_add_f32_dpp v201, v201, v201 row_ror:1 row_mask:0xf bank_mask:0xf
    ds_write_b64 v235, v[200:201]
    s_mov_b64 vcc, s[42:43]
    v_cndmask_b32_dpp v184, v90, v88, vcc row_ror:8 row_mask:0xf bank_mask:0xf
    v_cndmask_b32_dpp v185, v94, v92, vcc row_ror:8 row_mask:0xf bank_mask:0xf
    v_cndmask_b32_dpp v188, v91, v89, vcc row_ror:8 row_mask:0xf bank_mask:0xf
    v_cndmask_b32_dpp v189, v95, v93, vcc row_ror:8 row_mask:0xf bank_mask:0xf
    s_mov_b64 vcc, s[44:45]
    v_cndmask_b32_dpp v186, v88, v90, vcc row_ror:8 row_mask:0xf bank_mask:0xf
    v_cndmask_b32_dpp v187, v92, v94, vcc row_ror:8 row_mask:0xf bank_mask:0xf
    v_cndmask_b32_dpp v190, v89, v91, vcc row_ror:8 row_mask:0xf bank_mask:0xf
    v_cndmask_b32_dpp v191, v93, v95, vcc row_ror:8 row_mask:0xf bank_mask:0xf
    s_waitcnt lgkmcnt(0)
    v_mfma_f32_16x16x32_bf16 v[16:19], v[128:131], v[184:187], 0
    ds_read_b128 v[156:159], v10 offset:1024
    ds_read_b128 v[160:163], v10 offset:17408
    v_mfma_f32_16x16x32_bf16 v[20:23], v[128:131], v[188:191], 0
    ds_read_b128 v[164:167], v10 offset:33792
    ds_read_b128 v[168:171], v10 offset:50176
    v_mfma_f32_16x16x32_bf16 v[24:27], v[132:135], v[184:187], 0
    ds_read_b128 v[172:175], v11 offset:1024
    ds_read_b128 v[176:179], v11 offset:17408
    v_mfma_f32_16x16x32_bf16 v[28:31], v[132:135], v[188:191], 0
    ds_read_b128 v[180:183], v11 offset:33792
    s_barrier
    v_mfma_f32_16x16x32_bf16 v[32:35], v[136:139], v[184:187], 0
    buffer_load_dwordx4 v[88:91], v8, s[52:55], s23 offen sc1
    v_mfma_f32_16x16x32_bf16 v[36:39], v[136:139], v[188:191], 0
    buffer_load_dwordx4 v[92:95], v9, s[52:55], s23 offen sc1
    v_mfma_f32_16x16x32_bf16 v[40:43], v[140:143], v[184:187], 0
    buffer_load_dwordx4 a[112:115], v12, s[52:55], s33 offen offset:3072 sc1
    v_mfma_f32_16x16x32_bf16 v[44:47], v[140:143], v[188:191], 0
    v_cndmask_b32_dpp v194, v96, v98, vcc row_ror:8 row_mask:0xf bank_mask:0xf
    v_mfma_f32_16x16x32_bf16 v[48:51], v[144:147], v[184:187], 0
    v_cndmask_b32_dpp v195, v100, v102, vcc row_ror:8 row_mask:0xf bank_mask:0xf
    v_cndmask_b32_dpp v198, v97, v99, vcc row_ror:8 row_mask:0xf bank_mask:0xf
    v_mfma_f32_16x16x32_bf16 v[52:55], v[144:147], v[188:191], 0
    v_cndmask_b32_dpp v199, v101, v103, vcc row_ror:8 row_mask:0xf bank_mask:0xf
    s_mov_b64 vcc, s[42:43]
    v_mfma_f32_16x16x32_bf16 v[56:59], v[148:151], v[184:187], 0
    ds_read2_b32 v[216:217], v236 offset0:0 offset1:4
    ds_read2_b32 v[218:219], v236 offset0:8 offset1:12
    v_mfma_f32_16x16x32_bf16 v[60:63], v[148:151], v[188:191], 0
    v_cndmask_b32_dpp v192, v98, v96, vcc row_ror:8 row_mask:0xf bank_mask:0xf
    v_cndmask_b32_dpp v193, v102, v100, vcc row_ror:8 row_mask:0xf bank_mask:0xf
    v_mfma_f32_16x16x32_bf16 v[64:67], v[152:155], v[184:187], 0
    v_cndmask_b32_dpp v196, v99, v97, vcc row_ror:8 row_mask:0xf bank_mask:0xf
    v_cndmask_b32_dpp v197, v103, v101, vcc row_ror:8 row_mask:0xf bank_mask:0xf
    v_mfma_f32_16x16x32_bf16 v[68:71], v[152:155], v[188:191], 0
    ds_read2_b32 v[220:221], v236 offset0:16 offset1:20
    ds_read2_b32 v[222:223], v236 offset0:24 offset1:28
    s_waitcnt lgkmcnt(0)
    v_mfma_f32_16x16x32_bf16 v[16:19], v[156:159], v[192:195], v[16:19]
    ds_read_b128 v[128:131], v10 offset:2048
    ds_read_b128 v[132:135], v10 offset:18432
    v_mfma_f32_16x16x32_bf16 v[20:23], v[156:159], v[196:199], v[20:23]
    ds_read_b128 v[136:139], v10 offset:34816
    ds_read_b128 v[140:143], v10 offset:51200
    v_mfma_f32_16x16x32_bf16 v[24:27], v[160:163], v[192:195], v[24:27]
    ds_read_b128 v[144:147], v11 offset:2048
    ds_read_b128 v[148:151], v11 offset:18432
    v_mfma_f32_16x16x32_bf16 v[28:31], v[160:163], v[196:199], v[28:31]
    ds_read_b128 v[152:155], v11 offset:34816
    v_add_f32 v216, v216, v218
    v_mfma_f32_16x16x32_bf16 v[32:35], v[164:167], v[192:195], v[32:35]
    buffer_load_dwordx4 v[96:99], v8, s[52:55], s24 offen sc1
    v_mfma_f32_16x16x32_bf16 v[36:39], v[164:167], v[196:199], v[36:39]
    buffer_load_dwordx4 v[100:103], v9, s[52:55], s24 offen sc1
    v_mfma_f32_16x16x32_bf16 v[40:43], v[168:171], v[192:195], v[40:43]
    v_add_f32_e64 v217, v217, v219
    buffer_load_dwordx4 a[116:119], v13, s[52:55], s33 offen offset:3072 sc1
    v_mfma_f32_16x16x32_bf16 v[44:47], v[168:171], v[196:199], v[44:47]
    v_cndmask_b32_dpp v184, v106, v104, vcc row_ror:8 row_mask:0xf bank_mask:0xf
    v_mfma_f32_16x16x32_bf16 v[48:51], v[172:175], v[192:195], v[48:51]
    v_cndmask_b32_dpp v185, v110, v108, vcc row_ror:8 row_mask:0xf bank_mask:0xf
    v_cndmask_b32_dpp v188, v107, v105, vcc row_ror:8 row_mask:0xf bank_mask:0xf
    v_mfma_f32_16x16x32_bf16 v[52:55], v[172:175], v[196:199], v[52:55]
    v_cndmask_b32_dpp v189, v111, v109, vcc row_ror:8 row_mask:0xf bank_mask:0xf
    s_mov_b64 vcc, s[44:45]
    v_mfma_f32_16x16x32_bf16 v[56:59], v[176:179], v[192:195], v[56:59]
    v_add_f32 v216, v216, v220
    v_add_f32_e64 v217, v217, v221
    v_mfma_f32_16x16x32_bf16 v[60:63], v[176:179], v[196:199], v[60:63]
    v_cndmask_b32_dpp v186, v104, v106, vcc row_ror:8 row_mask:0xf bank_mask:0xf
    v_cndmask_b32_dpp v187, v108, v110, vcc row_ror:8 row_mask:0xf bank_mask:0xf
    v_mfma_f32_16x16x32_bf16 v[64:67], v[180:183], v[192:195], v[64:67]
    v_cndmask_b32_dpp v190, v105, v107, vcc row_ror:8 row_mask:0xf bank_mask:0xf
    v_cndmask_b32_dpp v191, v109, v111, vcc row_ror:8 row_mask:0xf bank_mask:0xf
    v_mfma_f32_16x16x32_bf16 v[68:71], v[180:183], v[196:199], v[68:71]
    v_add_f32 v216, v216, v222
    v_add_f32_e64 v217, v217, v223
    s_waitcnt lgkmcnt(0)
    v_mfma_f32_16x16x32_bf16 v[16:19], v[128:131], v[184:187], v[16:19]
    ds_read_b128 v[156:159], v10 offset:3072
    ds_read_b128 v[160:163], v10 offset:19456
    v_mfma_f32_16x16x32_bf16 v[20:23], v[128:131], v[188:191], v[20:23]
    ds_read_b128 v[164:167], v10 offset:35840
    ds_read_b128 v[168:171], v10 offset:52224
    v_mfma_f32_16x16x32_bf16 v[24:27], v[132:135], v[184:187], v[24:27]
    ds_read_b128 v[172:175], v11 offset:3072
    ds_read_b128 v[176:179], v11 offset:19456
    v_mfma_f32_16x16x32_bf16 v[28:31], v[132:135], v[188:191], v[28:31]
    ds_read_b128 v[180:183], v11 offset:35840
    v_mul_f32 v216, 0x3b000000, v216
    v_mfma_f32_16x16x32_bf16 v[32:35], v[136:139], v[184:187], v[32:35]
    buffer_load_dwordx4 v[104:107], v8, s[52:55], s25 offen sc1
    v_mfma_f32_16x16x32_bf16 v[36:39], v[136:139], v[188:191], v[36:39]
    buffer_load_dwordx4 v[108:111], v9, s[52:55], s25 offen sc1
    v_mfma_f32_16x16x32_bf16 v[40:43], v[140:143], v[184:187], v[40:43]
    v_mul_f32 v217, 0x3b000000, v217
    buffer_load_dwordx4 a[120:123], v14, s[52:55], s33 offen offset:3072 sc1
    v_mfma_f32_16x16x32_bf16 v[44:47], v[140:143], v[188:191], v[44:47]
    v_cndmask_b32_dpp v194, v112, v114, vcc row_ror:8 row_mask:0xf bank_mask:0xf
    v_mfma_f32_16x16x32_bf16 v[48:51], v[144:147], v[184:187], v[48:51]
    v_cndmask_b32_dpp v195, v116, v118, vcc row_ror:8 row_mask:0xf bank_mask:0xf
    v_cndmask_b32_dpp v198, v113, v115, vcc row_ror:8 row_mask:0xf bank_mask:0xf
    v_mfma_f32_16x16x32_bf16 v[52:55], v[144:147], v[188:191], v[52:55]
    v_cndmask_b32_dpp v199, v117, v119, vcc row_ror:8 row_mask:0xf bank_mask:0xf
    s_mov_b64 vcc, s[42:43]
    v_mfma_f32_16x16x32_bf16 v[56:59], v[148:151], v[184:187], v[56:59]
    v_fma_f32 v217, -v216, v216, v217
    v_max_f32 v217, 0, v217
    buffer_load_dwordx4 a[124:127], v15, s[52:55], s33 offen offset:3072 sc1
    v_mfma_f32_16x16x32_bf16 v[60:63], v[148:151], v[188:191], v[60:63]
    v_cndmask_b32_dpp v192, v114, v112, vcc row_ror:8 row_mask:0xf bank_mask:0xf
    v_cndmask_b32_dpp v193, v118, v116, vcc row_ror:8 row_mask:0xf bank_mask:0xf
    v_mfma_f32_16x16x32_bf16 v[64:67], v[152:155], v[184:187], v[64:67]
    v_cndmask_b32_dpp v196, v115, v113, vcc row_ror:8 row_mask:0xf bank_mask:0xf
    v_cndmask_b32_dpp v197, v119, v117, vcc row_ror:8 row_mask:0xf bank_mask:0xf
    v_mfma_f32_16x16x32_bf16 v[68:71], v[152:155], v[188:191], v[68:71]
    v_cvt_pk_bf16_f32 v218, v217, v217
    v_lshlrev_b32 v218, 16, v218
    s_waitcnt vmcnt(10)
    v_mov_b32 v242, s72
    s_mov_b64 exec, 1
    buffer_store_dword v242, off, s[52:55], s61 offset:16 sc1
    s_mov_b64 exec, -1
    s_waitcnt lgkmcnt(0)
    v_mfma_f32_16x16x32_bf16 v[16:19], v[156:159], v[192:195], v[16:19]
    ds_read_b128 v[128:131], v10 offset:4096
    ds_read_b128 v[132:135], v10 offset:20480
    v_mfma_f32_16x16x32_bf16 v[20:23], v[156:159], v[196:199], v[20:23]
    ds_read_b128 v[136:139], v10 offset:36864
    ds_read_b128 v[140:143], v10 offset:53248
    v_mfma_f32_16x16x32_bf16 v[24:27], v[160:163], v[192:195], v[24:27]
    ds_read_b128 v[144:147], v11 offset:4096
    ds_read_b128 v[148:151], v11 offset:20480
    v_mfma_f32_16x16x32_bf16 v[28:31], v[160:163], v[196:199], v[28:31]
    ds_read_b128 v[152:155], v11 offset:36864
    v_add_f32 v218, 0x3727c5ac, v218
    v_mfma_f32_16x16x32_bf16 v[32:35], v[164:167], v[192:195], v[32:35]
    buffer_load_dwordx4 v[112:115], v8, s[52:55], s26 offen sc1
    v_mfma_f32_16x16x32_bf16 v[36:39], v[164:167], v[196:199], v[36:39]
    buffer_load_dwordx4 v[116:119], v9, s[52:55], s26 offen sc1
    v_mfma_f32_16x16x32_bf16 v[40:43], v[168:171], v[192:195], v[40:43]
    v_cvt_pk_bf16_f32 v218, v218, v218
    buffer_load_dwordx4 a[128:131], v12, s[52:55], s34 offen offset:0 sc1
    v_mfma_f32_16x16x32_bf16 v[44:47], v[168:171], v[196:199], v[44:47]
    v_cndmask_b32_dpp v184, v122, v120, vcc row_ror:8 row_mask:0xf bank_mask:0xf
    v_mfma_f32_16x16x32_bf16 v[48:51], v[172:175], v[192:195], v[48:51]
    v_cndmask_b32_dpp v185, v126, v124, vcc row_ror:8 row_mask:0xf bank_mask:0xf
    v_cndmask_b32_dpp v188, v123, v121, vcc row_ror:8 row_mask:0xf bank_mask:0xf
    v_mfma_f32_16x16x32_bf16 v[52:55], v[172:175], v[196:199], v[52:55]
    v_cndmask_b32_dpp v189, v127, v125, vcc row_ror:8 row_mask:0xf bank_mask:0xf
    s_mov_b64 vcc, s[44:45]
    v_mfma_f32_16x16x32_bf16 v[56:59], v[176:179], v[192:195], v[56:59]
    v_lshlrev_b32 v218, 16, v218
    v_sqrt_f32_e64 v218, v218
    v_mfma_f32_16x16x32_bf16 v[60:63], v[176:179], v[196:199], v[60:63]
    v_cndmask_b32_dpp v186, v120, v122, vcc row_ror:8 row_mask:0xf bank_mask:0xf
    v_cndmask_b32_dpp v187, v124, v126, vcc row_ror:8 row_mask:0xf bank_mask:0xf
    v_mfma_f32_16x16x32_bf16 v[64:67], v[180:183], v[192:195], v[64:67]
    v_cndmask_b32_dpp v190, v121, v123, vcc row_ror:8 row_mask:0xf bank_mask:0xf
    v_cndmask_b32_dpp v191, v125, v127, vcc row_ror:8 row_mask:0xf bank_mask:0xf
    v_mfma_f32_16x16x32_bf16 v[68:71], v[180:183], v[196:199], v[68:71]
    v_cvt_pk_bf16_f32 v218, v218, v216
    v_mov_b32 v219, s72
    s_waitcnt lgkmcnt(0)
    v_mfma_f32_16x16x32_bf16 v[16:19], v[128:131], v[184:187], v[16:19]
    ds_read_b128 v[156:159], v10 offset:5120
    ds_read_b128 v[160:163], v10 offset:21504
    v_mfma_f32_16x16x32_bf16 v[20:23], v[128:131], v[188:191], v[20:23]
    ds_read_b128 v[164:167], v10 offset:37888
    ds_read_b128 v[168:171], v10 offset:54272
    v_mfma_f32_16x16x32_bf16 v[24:27], v[132:135], v[184:187], v[24:27]
    ds_read_b128 v[172:175], v11 offset:5120
    ds_read_b128 v[176:179], v11 offset:21504
    v_mfma_f32_16x16x32_bf16 v[28:31], v[132:135], v[188:191], v[28:31]
    ds_read_b128 v[180:183], v11 offset:37888
    v_mfma_f32_16x16x32_bf16 v[32:35], v[136:139], v[184:187], v[32:35]
    buffer_load_dwordx4 v[120:123], v8, s[52:55], s27 offen sc1
    v_mfma_f32_16x16x32_bf16 v[36:39], v[136:139], v[188:191], v[36:39]
    buffer_load_dwordx4 v[124:127], v9, s[52:55], s27 offen sc1
    v_mfma_f32_16x16x32_bf16 v[40:43], v[140:143], v[184:187], v[40:43]
    buffer_load_dwordx4 a[132:135], v13, s[52:55], s34 offen offset:0 sc1
    v_mfma_f32_16x16x32_bf16 v[44:47], v[140:143], v[188:191], v[44:47]
    v_cndmask_b32_dpp v194, v72, v74, vcc row_ror:8 row_mask:0xf bank_mask:0xf
    v_mfma_f32_16x16x32_bf16 v[48:51], v[144:147], v[184:187], v[48:51]
    v_cndmask_b32_dpp v195, v76, v78, vcc row_ror:8 row_mask:0xf bank_mask:0xf
    v_cndmask_b32_dpp v198, v73, v75, vcc row_ror:8 row_mask:0xf bank_mask:0xf
    v_mfma_f32_16x16x32_bf16 v[52:55], v[144:147], v[188:191], v[52:55]
    v_cndmask_b32_dpp v199, v77, v79, vcc row_ror:8 row_mask:0xf bank_mask:0xf
    s_mov_b64 vcc, s[42:43]
    v_mfma_f32_16x16x32_bf16 v[56:59], v[148:151], v[184:187], v[56:59]
    s_lshl_b32 s4, s92, 1
    s_add_u32 s4, s4, 0x7000
    s_mov_b64 exec, 15
    buffer_store_dwordx2 v[218:219], v237, s[52:55], s4 offen sc1
    s_mov_b64 exec, -1
    v_mfma_f32_16x16x32_bf16 v[60:63], v[148:151], v[188:191], v[60:63]
    v_cndmask_b32_dpp v192, v74, v72, vcc row_ror:8 row_mask:0xf bank_mask:0xf
    v_cndmask_b32_dpp v193, v78, v76, vcc row_ror:8 row_mask:0xf bank_mask:0xf
    v_mfma_f32_16x16x32_bf16 v[64:67], v[152:155], v[184:187], v[64:67]
    v_cndmask_b32_dpp v196, v75, v73, vcc row_ror:8 row_mask:0xf bank_mask:0xf
    v_cndmask_b32_dpp v197, v79, v77, vcc row_ror:8 row_mask:0xf bank_mask:0xf
    v_mfma_f32_16x16x32_bf16 v[68:71], v[152:155], v[188:191], v[68:71]
    s_waitcnt lgkmcnt(0)
    v_mfma_f32_16x16x32_bf16 v[16:19], v[156:159], v[192:195], v[16:19]
    ds_read_b128 v[128:131], v10 offset:6144
    ds_read_b128 v[132:135], v10 offset:22528
    v_mfma_f32_16x16x32_bf16 v[20:23], v[156:159], v[196:199], v[20:23]
    ds_read_b128 v[136:139], v10 offset:38912
    ds_read_b128 v[140:143], v10 offset:55296
    v_mfma_f32_16x16x32_bf16 v[24:27], v[160:163], v[192:195], v[24:27]
    ds_read_b128 v[144:147], v11 offset:6144
    ds_read_b128 v[148:151], v11 offset:22528
    v_mfma_f32_16x16x32_bf16 v[28:31], v[160:163], v[196:199], v[28:31]
    ds_read_b128 v[152:155], v11 offset:38912
    v_mfma_f32_16x16x32_bf16 v[32:35], v[164:167], v[192:195], v[32:35]
    buffer_load_dwordx4 v[72:75], v8, s[52:55], s28 offen sc1
    v_mfma_f32_16x16x32_bf16 v[36:39], v[164:167], v[196:199], v[36:39]
    buffer_load_dwordx4 v[76:79], v9, s[52:55], s28 offen sc1
    v_mfma_f32_16x16x32_bf16 v[40:43], v[168:171], v[192:195], v[40:43]
    buffer_load_dwordx4 a[136:139], v14, s[52:55], s34 offen offset:0 sc1
    v_mfma_f32_16x16x32_bf16 v[44:47], v[168:171], v[196:199], v[44:47]
    v_cndmask_b32_dpp v184, v82, v80, vcc row_ror:8 row_mask:0xf bank_mask:0xf
    v_mfma_f32_16x16x32_bf16 v[48:51], v[172:175], v[192:195], v[48:51]
    v_cndmask_b32_dpp v185, v86, v84, vcc row_ror:8 row_mask:0xf bank_mask:0xf
    v_cndmask_b32_dpp v188, v83, v81, vcc row_ror:8 row_mask:0xf bank_mask:0xf
    v_mfma_f32_16x16x32_bf16 v[52:55], v[172:175], v[196:199], v[52:55]
    v_cndmask_b32_dpp v189, v87, v85, vcc row_ror:8 row_mask:0xf bank_mask:0xf
    s_mov_b64 vcc, s[44:45]
    v_mfma_f32_16x16x32_bf16 v[56:59], v[176:179], v[192:195], v[56:59]
    buffer_load_dwordx4 a[140:143], v15, s[52:55], s34 offen offset:0 sc1
    v_mfma_f32_16x16x32_bf16 v[60:63], v[176:179], v[196:199], v[60:63]
    v_cndmask_b32_dpp v186, v80, v82, vcc row_ror:8 row_mask:0xf bank_mask:0xf
    v_cndmask_b32_dpp v187, v84, v86, vcc row_ror:8 row_mask:0xf bank_mask:0xf
    v_mfma_f32_16x16x32_bf16 v[64:67], v[180:183], v[192:195], v[64:67]
    v_cndmask_b32_dpp v190, v81, v83, vcc row_ror:8 row_mask:0xf bank_mask:0xf
    v_cndmask_b32_dpp v191, v85, v87, vcc row_ror:8 row_mask:0xf bank_mask:0xf
    v_mfma_f32_16x16x32_bf16 v[68:71], v[180:183], v[196:199], v[68:71]
    s_waitcnt lgkmcnt(0)
    v_mfma_f32_16x16x32_bf16 v[16:19], v[128:131], v[184:187], v[16:19]
    ds_read_b128 v[156:159], v10 offset:7168
    ds_read_b128 v[160:163], v10 offset:23552
    v_mfma_f32_16x16x32_bf16 v[20:23], v[128:131], v[188:191], v[20:23]
    ds_read_b128 v[164:167], v10 offset:39936
    ds_read_b128 v[168:171], v10 offset:56320
    v_mfma_f32_16x16x32_bf16 v[24:27], v[132:135], v[184:187], v[24:27]
    ds_read_b128 v[172:175], v11 offset:7168
    ds_read_b128 v[176:179], v11 offset:23552
    v_mfma_f32_16x16x32_bf16 v[28:31], v[132:135], v[188:191], v[28:31]
    ds_read_b128 v[180:183], v11 offset:39936
    v_mfma_f32_16x16x32_bf16 v[32:35], v[136:139], v[184:187], v[32:35]
    buffer_load_dwordx4 v[80:83], v8, s[52:55], s29 offen sc1
    v_mfma_f32_16x16x32_bf16 v[36:39], v[136:139], v[188:191], v[36:39]
    buffer_load_dwordx4 v[84:87], v9, s[52:55], s29 offen sc1
    v_mfma_f32_16x16x32_bf16 v[40:43], v[140:143], v[184:187], v[40:43]
    buffer_load_dwordx4 a[144:147], v12, s[52:55], s34 offen offset:1024 sc1
    v_mfma_f32_16x16x32_bf16 v[44:47], v[140:143], v[188:191], v[44:47]
    s_waitcnt vmcnt(23)
    v_cndmask_b32_dpp v194, v88, v90, vcc row_ror:8 row_mask:0xf bank_mask:0xf
    v_mfma_f32_16x16x32_bf16 v[48:51], v[144:147], v[184:187], v[48:51]
    v_cndmask_b32_dpp v195, v92, v94, vcc row_ror:8 row_mask:0xf bank_mask:0xf
    v_cndmask_b32_dpp v198, v89, v91, vcc row_ror:8 row_mask:0xf bank_mask:0xf
    v_mfma_f32_16x16x32_bf16 v[52:55], v[144:147], v[188:191], v[52:55]
    v_cndmask_b32_dpp v199, v93, v95, vcc row_ror:8 row_mask:0xf bank_mask:0xf
    s_mov_b64 vcc, s[42:43]
    v_mfma_f32_16x16x32_bf16 v[56:59], v[148:151], v[184:187], v[56:59]
    v_mfma_f32_16x16x32_bf16 v[60:63], v[148:151], v[188:191], v[60:63]
    v_cndmask_b32_dpp v192, v90, v88, vcc row_ror:8 row_mask:0xf bank_mask:0xf
    v_cndmask_b32_dpp v193, v94, v92, vcc row_ror:8 row_mask:0xf bank_mask:0xf
    v_mfma_f32_16x16x32_bf16 v[64:67], v[152:155], v[184:187], v[64:67]
    v_cndmask_b32_dpp v196, v91, v89, vcc row_ror:8 row_mask:0xf bank_mask:0xf
    v_cndmask_b32_dpp v197, v95, v93, vcc row_ror:8 row_mask:0xf bank_mask:0xf
    v_mfma_f32_16x16x32_bf16 v[68:71], v[152:155], v[188:191], v[68:71]
    s_waitcnt lgkmcnt(0)
    v_mfma_f32_16x16x32_bf16 v[16:19], v[156:159], v[192:195], v[16:19]
    ds_read_b128 v[128:131], v10 offset:8192
    ds_read_b128 v[132:135], v10 offset:24576
    v_mfma_f32_16x16x32_bf16 v[20:23], v[156:159], v[196:199], v[20:23]
    ds_read_b128 v[136:139], v10 offset:40960
    ds_read_b128 v[140:143], v10 offset:57344
    v_mfma_f32_16x16x32_bf16 v[24:27], v[160:163], v[192:195], v[24:27]
    ds_read_b128 v[144:147], v11 offset:8192
    ds_read_b128 v[148:151], v11 offset:24576
    v_mfma_f32_16x16x32_bf16 v[28:31], v[160:163], v[196:199], v[28:31]
    ds_read_b128 v[152:155], v11 offset:40960
    v_mfma_f32_16x16x32_bf16 v[32:35], v[164:167], v[192:195], v[32:35]
    buffer_load_dwordx4 v[88:91], v8, s[52:55], s30 offen sc1
    v_mfma_f32_16x16x32_bf16 v[36:39], v[164:167], v[196:199], v[36:39]
    buffer_load_dwordx4 v[92:95], v9, s[52:55], s30 offen sc1
    v_mfma_f32_16x16x32_bf16 v[40:43], v[168:171], v[192:195], v[40:43]
    buffer_load_dwordx4 a[148:151], v13, s[52:55], s34 offen offset:1024 sc1
    v_mfma_f32_16x16x32_bf16 v[44:47], v[168:171], v[196:199], v[44:47]
    s_waitcnt vmcnt(23)
    v_cndmask_b32_dpp v184, v98, v96, vcc row_ror:8 row_mask:0xf bank_mask:0xf
    v_mfma_f32_16x16x32_bf16 v[48:51], v[172:175], v[192:195], v[48:51]
    v_cndmask_b32_dpp v185, v102, v100, vcc row_ror:8 row_mask:0xf bank_mask:0xf
    v_cndmask_b32_dpp v188, v99, v97, vcc row_ror:8 row_mask:0xf bank_mask:0xf
    v_mfma_f32_16x16x32_bf16 v[52:55], v[172:175], v[196:199], v[52:55]
    v_cndmask_b32_dpp v189, v103, v101, vcc row_ror:8 row_mask:0xf bank_mask:0xf
    s_mov_b64 vcc, s[44:45]
    v_mfma_f32_16x16x32_bf16 v[56:59], v[176:179], v[192:195], v[56:59]
    v_mfma_f32_16x16x32_bf16 v[60:63], v[176:179], v[196:199], v[60:63]
    v_cndmask_b32_dpp v186, v96, v98, vcc row_ror:8 row_mask:0xf bank_mask:0xf
    v_cndmask_b32_dpp v187, v100, v102, vcc row_ror:8 row_mask:0xf bank_mask:0xf
    v_mfma_f32_16x16x32_bf16 v[64:67], v[180:183], v[192:195], v[64:67]
    v_cndmask_b32_dpp v190, v97, v99, vcc row_ror:8 row_mask:0xf bank_mask:0xf
    v_cndmask_b32_dpp v191, v101, v103, vcc row_ror:8 row_mask:0xf bank_mask:0xf
    v_mfma_f32_16x16x32_bf16 v[68:71], v[180:183], v[196:199], v[68:71]
    s_waitcnt lgkmcnt(0)
    v_mfma_f32_16x16x32_bf16 v[16:19], v[128:131], v[184:187], v[16:19]
    ds_read_b128 v[156:159], v10 offset:9216
    ds_read_b128 v[160:163], v10 offset:25600
    v_mfma_f32_16x16x32_bf16 v[20:23], v[128:131], v[188:191], v[20:23]
    ds_read_b128 v[164:167], v10 offset:41984
    ds_read_b128 v[168:171], v10 offset:58368
    v_mfma_f32_16x16x32_bf16 v[24:27], v[132:135], v[184:187], v[24:27]
    ds_read_b128 v[172:175], v11 offset:9216
    ds_read_b128 v[176:179], v11 offset:25600
    v_mfma_f32_16x16x32_bf16 v[28:31], v[132:135], v[188:191], v[28:31]
    ds_read_b128 v[180:183], v11 offset:41984
    v_mfma_f32_16x16x32_bf16 v[32:35], v[136:139], v[184:187], v[32:35]
    buffer_load_dwordx4 v[96:99], v8, s[52:55], s31 offen sc1
    v_mfma_f32_16x16x32_bf16 v[36:39], v[136:139], v[188:191], v[36:39]
    buffer_load_dwordx4 v[100:103], v9, s[52:55], s31 offen sc1
    v_mfma_f32_16x16x32_bf16 v[40:43], v[140:143], v[184:187], v[40:43]
    buffer_load_dwordx4 a[152:155], v14, s[52:55], s34 offen offset:1024 sc1
    v_mfma_f32_16x16x32_bf16 v[44:47], v[140:143], v[188:191], v[44:47]
    s_waitcnt vmcnt(23)
    v_cndmask_b32_dpp v194, v104, v106, vcc row_ror:8 row_mask:0xf bank_mask:0xf
    v_mfma_f32_16x16x32_bf16 v[48:51], v[144:147], v[184:187], v[48:51]
    v_cndmask_b32_dpp v195, v108, v110, vcc row_ror:8 row_mask:0xf bank_mask:0xf
    v_cndmask_b32_dpp v198, v105, v107, vcc row_ror:8 row_mask:0xf bank_mask:0xf
    v_mfma_f32_16x16x32_bf16 v[52:55], v[144:147], v[188:191], v[52:55]
    v_cndmask_b32_dpp v199, v109, v111, vcc row_ror:8 row_mask:0xf bank_mask:0xf
    s_mov_b64 vcc, s[42:43]
    v_mfma_f32_16x16x32_bf16 v[56:59], v[148:151], v[184:187], v[56:59]
    buffer_load_dwordx4 a[156:159], v15, s[52:55], s34 offen offset:1024 sc1
    v_mfma_f32_16x16x32_bf16 v[60:63], v[148:151], v[188:191], v[60:63]
    v_cndmask_b32_dpp v192, v106, v104, vcc row_ror:8 row_mask:0xf bank_mask:0xf
    v_cndmask_b32_dpp v193, v110, v108, vcc row_ror:8 row_mask:0xf bank_mask:0xf
    v_mfma_f32_16x16x32_bf16 v[64:67], v[152:155], v[184:187], v[64:67]
    v_cndmask_b32_dpp v196, v107, v105, vcc row_ror:8 row_mask:0xf bank_mask:0xf
    v_cndmask_b32_dpp v197, v111, v109, vcc row_ror:8 row_mask:0xf bank_mask:0xf
    v_mfma_f32_16x16x32_bf16 v[68:71], v[152:155], v[188:191], v[68:71]
    s_waitcnt lgkmcnt(0)
    v_mfma_f32_16x16x32_bf16 v[16:19], v[156:159], v[192:195], v[16:19]
    ds_read_b128 v[128:131], v10 offset:10240
    ds_read_b128 v[132:135], v10 offset:26624
    v_mfma_f32_16x16x32_bf16 v[20:23], v[156:159], v[196:199], v[20:23]
    ds_read_b128 v[136:139], v10 offset:43008
    ds_read_b128 v[140:143], v10 offset:59392
    v_mfma_f32_16x16x32_bf16 v[24:27], v[160:163], v[192:195], v[24:27]
    ds_read_b128 v[144:147], v11 offset:10240
    ds_read_b128 v[148:151], v11 offset:26624
    v_mfma_f32_16x16x32_bf16 v[28:31], v[160:163], v[196:199], v[28:31]
    ds_read_b128 v[152:155], v11 offset:43008
    v_mfma_f32_16x16x32_bf16 v[32:35], v[164:167], v[192:195], v[32:35]
    buffer_load_dwordx4 a[160:163], v12, s[52:55], s34 offen offset:2048 sc1
    v_mfma_f32_16x16x32_bf16 v[36:39], v[164:167], v[196:199], v[36:39]
    buffer_load_dwordx4 a[164:167], v13, s[52:55], s34 offen offset:2048 sc1
    v_mfma_f32_16x16x32_bf16 v[40:43], v[168:171], v[192:195], v[40:43]
    buffer_load_dwordx4 a[168:171], v14, s[52:55], s34 offen offset:2048 sc1
    v_mfma_f32_16x16x32_bf16 v[44:47], v[168:171], v[196:199], v[44:47]
    s_waitcnt vmcnt(22)
    v_cndmask_b32_dpp v184, v114, v112, vcc row_ror:8 row_mask:0xf bank_mask:0xf
    v_mfma_f32_16x16x32_bf16 v[48:51], v[172:175], v[192:195], v[48:51]
    v_cndmask_b32_dpp v185, v118, v116, vcc row_ror:8 row_mask:0xf bank_mask:0xf
    v_cndmask_b32_dpp v188, v115, v113, vcc row_ror:8 row_mask:0xf bank_mask:0xf
    v_mfma_f32_16x16x32_bf16 v[52:55], v[172:175], v[196:199], v[52:55]
    v_cndmask_b32_dpp v189, v119, v117, vcc row_ror:8 row_mask:0xf bank_mask:0xf
    s_mov_b64 vcc, s[44:45]
    v_mfma_f32_16x16x32_bf16 v[56:59], v[176:179], v[192:195], v[56:59]
    buffer_load_dwordx4 a[172:175], v15, s[52:55], s34 offen offset:2048 sc1
    v_mfma_f32_16x16x32_bf16 v[60:63], v[176:179], v[196:199], v[60:63]
    v_cndmask_b32_dpp v186, v112, v114, vcc row_ror:8 row_mask:0xf bank_mask:0xf
    v_cndmask_b32_dpp v187, v116, v118, vcc row_ror:8 row_mask:0xf bank_mask:0xf
    v_mfma_f32_16x16x32_bf16 v[64:67], v[180:183], v[192:195], v[64:67]
    v_cndmask_b32_dpp v190, v113, v115, vcc row_ror:8 row_mask:0xf bank_mask:0xf
    v_cndmask_b32_dpp v191, v117, v119, vcc row_ror:8 row_mask:0xf bank_mask:0xf
    v_mfma_f32_16x16x32_bf16 v[68:71], v[180:183], v[196:199], v[68:71]
    s_waitcnt lgkmcnt(0)
    v_mfma_f32_16x16x32_bf16 v[16:19], v[128:131], v[184:187], v[16:19]
    ds_read_b128 v[156:159], v10 offset:11264
    ds_read_b128 v[160:163], v10 offset:27648
    v_mfma_f32_16x16x32_bf16 v[20:23], v[128:131], v[188:191], v[20:23]
    ds_read_b128 v[164:167], v10 offset:44032
    ds_read_b128 v[168:171], v10 offset:60416
    v_mfma_f32_16x16x32_bf16 v[24:27], v[132:135], v[184:187], v[24:27]
    ds_read_b128 v[172:175], v11 offset:11264
    ds_read_b128 v[176:179], v11 offset:27648
    v_mfma_f32_16x16x32_bf16 v[28:31], v[132:135], v[188:191], v[28:31]
    ds_read_b128 v[180:183], v11 offset:44032
    v_mfma_f32_16x16x32_bf16 v[32:35], v[136:139], v[184:187], v[32:35]
    buffer_load_dwordx4 v[200:203], v240, s[52:55], s93 offen offset:16 sc1
    v_mfma_f32_16x16x32_bf16 v[36:39], v[136:139], v[188:191], v[36:39]
    buffer_load_dwordx4 a[176:179], v12, s[52:55], s34 offen offset:3072 sc1
    v_mfma_f32_16x16x32_bf16 v[40:43], v[140:143], v[184:187], v[40:43]
    buffer_load_dwordx4 a[180:183], v13, s[52:55], s34 offen offset:3072 sc1
    v_mfma_f32_16x16x32_bf16 v[44:47], v[140:143], v[188:191], v[44:47]
    s_waitcnt vmcnt(23)
    v_cndmask_b32_dpp v194, v120, v122, vcc row_ror:8 row_mask:0xf bank_mask:0xf
    v_mfma_f32_16x16x32_bf16 v[48:51], v[144:147], v[184:187], v[48:51]
    v_cndmask_b32_dpp v195, v124, v126, vcc row_ror:8 row_mask:0xf bank_mask:0xf
    v_cndmask_b32_dpp v198, v121, v123, vcc row_ror:8 row_mask:0xf bank_mask:0xf
    v_mfma_f32_16x16x32_bf16 v[52:55], v[144:147], v[188:191], v[52:55]
    v_cndmask_b32_dpp v199, v125, v127, vcc row_ror:8 row_mask:0xf bank_mask:0xf
    s_mov_b64 vcc, s[42:43]
    v_mfma_f32_16x16x32_bf16 v[56:59], v[148:151], v[184:187], v[56:59]
    buffer_load_dwordx4 a[184:187], v14, s[52:55], s34 offen offset:3072 sc1
    v_mfma_f32_16x16x32_bf16 v[60:63], v[148:151], v[188:191], v[60:63]
    v_cndmask_b32_dpp v192, v122, v120, vcc row_ror:8 row_mask:0xf bank_mask:0xf
    v_cndmask_b32_dpp v193, v126, v124, vcc row_ror:8 row_mask:0xf bank_mask:0xf
    v_mfma_f32_16x16x32_bf16 v[64:67], v[152:155], v[184:187], v[64:67]
    v_cndmask_b32_dpp v196, v123, v121, vcc row_ror:8 row_mask:0xf bank_mask:0xf
    v_cndmask_b32_dpp v197, v127, v125, vcc row_ror:8 row_mask:0xf bank_mask:0xf
    v_mfma_f32_16x16x32_bf16 v[68:71], v[152:155], v[188:191], v[68:71]
    buffer_load_dwordx4 a[188:191], v15, s[52:55], s34 offen offset:3072 sc1
    s_waitcnt lgkmcnt(0)
    v_mfma_f32_16x16x32_bf16 v[16:19], v[156:159], v[192:195], v[16:19]
    ds_read_b128 v[128:131], v10 offset:12288
    ds_read_b128 v[132:135], v10 offset:28672
    v_mfma_f32_16x16x32_bf16 v[20:23], v[156:159], v[196:199], v[20:23]
    ds_read_b128 v[136:139], v10 offset:45056
    ds_read_b128 v[140:143], v10 offset:61440
    v_mfma_f32_16x16x32_bf16 v[24:27], v[160:163], v[192:195], v[24:27]
    ds_read_b128 v[144:147], v11 offset:12288
    ds_read_b128 v[148:151], v11 offset:28672
    v_mfma_f32_16x16x32_bf16 v[28:31], v[160:163], v[196:199], v[28:31]
    ds_read_b128 v[152:155], v11 offset:45056
    v_mfma_f32_16x16x32_bf16 v[32:35], v[164:167], v[192:195], v[32:35]
    buffer_load_dwordx4 a[192:195], v12, s[52:55], s35 offen offset:0 sc1
    v_mfma_f32_16x16x32_bf16 v[36:39], v[164:167], v[196:199], v[36:39]
    buffer_load_dwordx4 a[196:199], v13, s[52:55], s35 offen offset:0 sc1
    v_mfma_f32_16x16x32_bf16 v[40:43], v[168:171], v[192:195], v[40:43]
    buffer_load_dwordx4 a[200:203], v14, s[52:55], s35 offen offset:0 sc1
    v_mfma_f32_16x16x32_bf16 v[44:47], v[168:171], v[196:199], v[44:47]
    s_waitcnt vmcnt(24)
    v_cndmask_b32_dpp v184, v74, v72, vcc row_ror:8 row_mask:0xf bank_mask:0xf
    v_mfma_f32_16x16x32_bf16 v[48:51], v[172:175], v[192:195], v[48:51]
    v_cndmask_b32_dpp v185, v78, v76, vcc row_ror:8 row_mask:0xf bank_mask:0xf
    v_cndmask_b32_dpp v188, v75, v73, vcc row_ror:8 row_mask:0xf bank_mask:0xf
    v_mfma_f32_16x16x32_bf16 v[52:55], v[172:175], v[196:199], v[52:55]
    v_cndmask_b32_dpp v189, v79, v77, vcc row_ror:8 row_mask:0xf bank_mask:0xf
    s_mov_b64 vcc, s[44:45]
    v_mfma_f32_16x16x32_bf16 v[56:59], v[176:179], v[192:195], v[56:59]
    buffer_load_dwordx4 a[204:207], v15, s[52:55], s35 offen offset:0 sc1
    v_mfma_f32_16x16x32_bf16 v[60:63], v[176:179], v[196:199], v[60:63]
    v_cndmask_b32_dpp v186, v72, v74, vcc row_ror:8 row_mask:0xf bank_mask:0xf
    v_cndmask_b32_dpp v187, v76, v78, vcc row_ror:8 row_mask:0xf bank_mask:0xf
    v_mfma_f32_16x16x32_bf16 v[64:67], v[180:183], v[192:195], v[64:67]
    v_cndmask_b32_dpp v190, v73, v75, vcc row_ror:8 row_mask:0xf bank_mask:0xf
    v_cndmask_b32_dpp v191, v77, v79, vcc row_ror:8 row_mask:0xf bank_mask:0xf
    v_mfma_f32_16x16x32_bf16 v[68:71], v[180:183], v[196:199], v[68:71]
    s_waitcnt lgkmcnt(0)
    v_mfma_f32_16x16x32_bf16 v[16:19], v[128:131], v[184:187], v[16:19]
    ds_read_b128 v[156:159], v10 offset:13312
    ds_read_b128 v[160:163], v10 offset:29696
    v_mfma_f32_16x16x32_bf16 v[20:23], v[128:131], v[188:191], v[20:23]
    ds_read_b128 v[164:167], v10 offset:46080
    ds_read_b128 v[168:171], v10 offset:62464
    v_mfma_f32_16x16x32_bf16 v[24:27], v[132:135], v[184:187], v[24:27]
    ds_read_b128 v[172:175], v11 offset:13312
    ds_read_b128 v[176:179], v11 offset:29696
    v_mfma_f32_16x16x32_bf16 v[28:31], v[132:135], v[188:191], v[28:31]
    ds_read_b128 v[180:183], v11 offset:46080
    v_mfma_f32_16x16x32_bf16 v[32:35], v[136:139], v[184:187], v[32:35]
    s_add_u32 s94, s94, 0x2000
    buffer_load_dwordx4 v[228:231], v239, s[52:55], s94 offen sc1
    v_mfma_f32_16x16x32_bf16 v[36:39], v[136:139], v[188:191], v[36:39]
    buffer_load_dwordx4 a[208:211], v12, s[52:55], s35 offen offset:1024 sc1
    v_mfma_f32_16x16x32_bf16 v[40:43], v[140:143], v[184:187], v[40:43]
    buffer_load_dwordx4 a[212:215], v13, s[52:55], s35 offen offset:1024 sc1
    v_mfma_f32_16x16x32_bf16 v[44:47], v[140:143], v[188:191], v[44:47]
    s_waitcnt vmcnt(24)
    v_cndmask_b32_dpp v194, v80, v82, vcc row_ror:8 row_mask:0xf bank_mask:0xf
    v_mfma_f32_16x16x32_bf16 v[48:51], v[144:147], v[184:187], v[48:51]
    v_cndmask_b32_dpp v195, v84, v86, vcc row_ror:8 row_mask:0xf bank_mask:0xf
    v_cndmask_b32_dpp v198, v81, v83, vcc row_ror:8 row_mask:0xf bank_mask:0xf
    v_mfma_f32_16x16x32_bf16 v[52:55], v[144:147], v[188:191], v[52:55]
    v_cndmask_b32_dpp v199, v85, v87, vcc row_ror:8 row_mask:0xf bank_mask:0xf
    s_mov_b64 vcc, s[42:43]
    v_mfma_f32_16x16x32_bf16 v[56:59], v[148:151], v[184:187], v[56:59]
    buffer_load_dwordx4 a[216:219], v14, s[52:55], s35 offen offset:1024 sc1
    v_mfma_f32_16x16x32_bf16 v[60:63], v[148:151], v[188:191], v[60:63]
    v_cndmask_b32_dpp v192, v82, v80, vcc row_ror:8 row_mask:0xf bank_mask:0xf
    v_cndmask_b32_dpp v193, v86, v84, vcc row_ror:8 row_mask:0xf bank_mask:0xf
    v_mfma_f32_16x16x32_bf16 v[64:67], v[152:155], v[184:187], v[64:67]
    v_cndmask_b32_dpp v196, v83, v81, vcc row_ror:8 row_mask:0xf bank_mask:0xf
    v_cndmask_b32_dpp v197, v87, v85, vcc row_ror:8 row_mask:0xf bank_mask:0xf
    v_mfma_f32_16x16x32_bf16 v[68:71], v[152:155], v[188:191], v[68:71]
    buffer_load_dwordx4 a[220:223], v15, s[52:55], s35 offen offset:1024 sc1
    s_waitcnt vmcnt(13)
L_ha_chk:
    v_min3_u32 v242, v200, v201, s72
    v_max3_u32 v243, v200, v201, s72
    v_min3_u32 v242, v202, v203, v242
    v_max3_u32 v243, v202, v203, v243
    v_cmp_ne_u32 vcc, v242, v243
    s_cbranch_vccz L_ha_ok
    s_sub_u32 s12, s12, 1
    s_cmp_lt_i32 s12, 0
    s_cbranch_scc1 L_ha_ok
    s_sleep 4
    buffer_load_dwordx4 v[200:203], v240, s[52:55], s93 offen offset:16 sc1
    s_waitcnt vmcnt(0)
    s_branch L_ha_chk
L_ha_ok:
    s_mov_b64 vcc, s[42:43]
    s_waitcnt lgkmcnt(0)
    v_mfma_f32_16x16x32_bf16 v[16:19], v[156:159], v[192:195], v[16:19]
    ds_read_b128 v[128:131], v10 offset:14336
    ds_read_b128 v[132:135], v10 offset:30720
    v_mfma_f32_16x16x32_bf16 v[20:23], v[156:159], v[196:199], v[20:23]
    ds_read_b128 v[136:139], v10 offset:47104
    ds_read_b128 v[140:143], v10 offset:63488
    v_mfma_f32_16x16x32_bf16 v[24:27], v[160:163], v[192:195], v[24:27]
    ds_read_b128 v[144:147], v11 offset:14336
    ds_read_b128 v[148:151], v11 offset:30720
    v_mfma_f32_16x16x32_bf16 v[28:31], v[160:163], v[196:199], v[28:31]
    ds_read_b128 v[152:155], v11 offset:47104
    v_mfma_f32_16x16x32_bf16 v[32:35], v[164:167], v[192:195], v[32:35]
    buffer_load_dwordx4 v[104:107], v244, s[52:55], s16 offen sc1
    v_mfma_f32_16x16x32_bf16 v[36:39], v[164:167], v[196:199], v[36:39]
    buffer_load_dwordx4 v[108:111], v245, s[52:55], s16 offen sc1
    v_mfma_f32_16x16x32_bf16 v[40:43], v[168:171], v[192:195], v[40:43]
    buffer_load_dwordx4 v[112:115], v244, s[52:55], s17 offen sc1
    v_mfma_f32_16x16x32_bf16 v[44:47], v[168:171], v[196:199], v[44:47]
    v_cndmask_b32_dpp v184, v90, v88, vcc row_ror:8 row_mask:0xf bank_mask:0xf
    v_mfma_f32_16x16x32_bf16 v[48:51], v[172:175], v[192:195], v[48:51]
    v_cndmask_b32_dpp v185, v94, v92, vcc row_ror:8 row_mask:0xf bank_mask:0xf
    v_cndmask_b32_dpp v188, v91, v89, vcc row_ror:8 row_mask:0xf bank_mask:0xf
    v_mfma_f32_16x16x32_bf16 v[52:55], v[172:175], v[196:199], v[52:55]
    v_cndmask_b32_dpp v189, v95, v93, vcc row_ror:8 row_mask:0xf bank_mask:0xf
    s_mov_b64 vcc, s[44:45]
    v_mfma_f32_16x16x32_bf16 v[56:59], v[176:179], v[192:195], v[56:59]
    buffer_load_dwordx4 v[116:119], v245, s[52:55], s17 offen sc1
    v_mfma_f32_16x16x32_bf16 v[60:63], v[176:179], v[196:199], v[60:63]
    v_cndmask_b32_dpp v186, v88, v90, vcc row_ror:8 row_mask:0xf bank_mask:0xf
    v_cndmask_b32_dpp v187, v92, v94, vcc row_ror:8 row_mask:0xf bank_mask:0xf
    v_mfma_f32_16x16x32_bf16 v[64:67], v[180:183], v[192:195], v[64:67]
    v_cndmask_b32_dpp v190, v89, v91, vcc row_ror:8 row_mask:0xf bank_mask:0xf
    v_cndmask_b32_dpp v191, v93, v95, vcc row_ror:8 row_mask:0xf bank_mask:0xf
    v_mfma_f32_16x16x32_bf16 v[68:71], v[180:183], v[196:199], v[68:71]
    s_waitcnt lgkmcnt(0)
    v_mfma_f32_16x16x32_bf16 v[16:19], v[128:131], v[184:187], v[16:19]
    ds_read_b128 v[156:159], v10 offset:15360
    ds_read_b128 v[160:163], v10 offset:31744
    v_mfma_f32_16x16x32_bf16 v[20:23], v[128:131], v[188:191], v[20:23]
    ds_read_b128 v[164:167], v10 offset:48128
    ds_read_b128 v[168:171], v10 offset:64512
    v_mfma_f32_16x16x32_bf16 v[24:27], v[132:135], v[184:187], v[24:27]
    ds_read_b128 v[172:175], v11 offset:15360
    ds_read_b128 v[176:179], v11 offset:31744
    v_mfma_f32_16x16x32_bf16 v[28:31], v[132:135], v[188:191], v[28:31]
    ds_read_b128 v[180:183], v11 offset:48128
    v_mfma_f32_16x16x32_bf16 v[32:35], v[136:139], v[184:187], v[32:35]
    buffer_load_dwordx4 v[120:123], v244, s[52:55], s18 offen sc1
    v_mfma_f32_16x16x32_bf16 v[36:39], v[136:139], v[188:191], v[36:39]
    buffer_load_dwordx4 v[124:127], v245, s[52:55], s18 offen sc1
    v_mfma_f32_16x16x32_bf16 v[40:43], v[140:143], v[184:187], v[40:43]
    buffer_load_dwordx4 v[72:75], v244, s[52:55], s19 offen sc1
    v_mfma_f32_16x16x32_bf16 v[44:47], v[140:143], v[188:191], v[44:47]
    v_cndmask_b32_dpp v194, v96, v98, vcc row_ror:8 row_mask:0xf bank_mask:0xf
    v_mfma_f32_16x16x32_bf16 v[48:51], v[144:147], v[184:187], v[48:51]
    v_cndmask_b32_dpp v195, v100, v102, vcc row_ror:8 row_mask:0xf bank_mask:0xf
    v_cndmask_b32_dpp v198, v97, v99, vcc row_ror:8 row_mask:0xf bank_mask:0xf
    v_mfma_f32_16x16x32_bf16 v[52:55], v[144:147], v[188:191], v[52:55]
    v_cndmask_b32_dpp v199, v101, v103, vcc row_ror:8 row_mask:0xf bank_mask:0xf
    s_mov_b64 vcc, s[42:43]
    v_mfma_f32_16x16x32_bf16 v[56:59], v[148:151], v[184:187], v[56:59]
    buffer_load_dwordx4 v[76:79], v245, s[52:55], s19 offen sc1
    v_mfma_f32_16x16x32_bf16 v[60:63], v[148:151], v[188:191], v[60:63]
    v_cndmask_b32_dpp v192, v98, v96, vcc row_ror:8 row_mask:0xf bank_mask:0xf
    v_cndmask_b32_dpp v193, v102, v100, vcc row_ror:8 row_mask:0xf bank_mask:0xf
    v_mfma_f32_16x16x32_bf16 v[64:67], v[152:155], v[184:187], v[64:67]
    v_cndmask_b32_dpp v196, v99, v97, vcc row_ror:8 row_mask:0xf bank_mask:0xf
    v_cndmask_b32_dpp v197, v103, v101, vcc row_ror:8 row_mask:0xf bank_mask:0xf
    v_mfma_f32_16x16x32_bf16 v[68:71], v[152:155], v[188:191], v[68:71]
    s_waitcnt lgkmcnt(0)
    v_mfma_f32_16x16x32_bf16 v[16:19], v[156:159], v[192:195], v[16:19]
    ds_read_b128 v[128:131], v233 offset:0
    v_mfma_f32_16x16x32_bf16 v[20:23], v[156:159], v[196:199], v[20:23]
    ds_read_b128 v[132:135], v233 offset:64
    v_mfma_f32_16x16x32_bf16 v[24:27], v[160:163], v[192:195], v[24:27]
    ds_read_b128 v[136:139], v233 offset:128
    v_mfma_f32_16x16x32_bf16 v[28:31], v[160:163], v[196:199], v[28:31]
    ds_read_b128 v[140:143], v233 offset:192
    v_mfma_f32_16x16x32_bf16 v[32:35], v[164:167], v[192:195], v[32:35]
    ds_read_b128 v[144:147], v233 offset:256
    buffer_load_dwordx4 v[80:83], v244, s[52:55], s20 offen sc1
    v_mfma_f32_16x16x32_bf16 v[36:39], v[164:167], v[196:199], v[36:39]
    ds_read_b128 v[148:151], v233 offset:320
    buffer_load_dwordx4 v[84:87], v245, s[52:55], s20 offen sc1
    v_mfma_f32_16x16x32_bf16 v[40:43], v[168:171], v[192:195], v[40:43]
    buffer_load_dwordx4 v[88:91], v244, s[52:55], s21 offen sc1
    v_mfma_f32_16x16x32_bf16 v[44:47], v[168:171], v[196:199], v[44:47]
    v_mfma_f32_16x16x32_bf16 v[48:51], v[172:175], v[192:195], v[48:51]
    v_mfma_f32_16x16x32_bf16 v[52:55], v[172:175], v[196:199], v[52:55]
    v_mfma_f32_16x16x32_bf16 v[56:59], v[176:179], v[192:195], v[56:59]
    buffer_load_dwordx4 v[92:95], v245, s[52:55], s21 offen sc1
    v_mfma_f32_16x16x32_bf16 v[60:63], v[176:179], v[196:199], v[60:63]
    v_mfma_f32_16x16x32_bf16 v[64:67], v[180:183], v[192:195], v[64:67]
    v_mfma_f32_16x16x32_bf16 v[68:71], v[180:183], v[196:199], v[68:71]
    buffer_load_dwordx4 v[96:99], v244, s[52:55], s22 offen sc1
    buffer_load_dwordx4 v[100:103], v245, s[52:55], s22 offen sc1
    s_waitcnt vmcnt(18)
L_s21_chk:
    v_min3_u32 v242, v229, v231, s72
    v_max3_u32 v243, v229, v231, s72
    v_cmp_ne_u32 vcc, v242, v243
    s_cbranch_vccz L_s21_ok
    s_sub_u32 s12, s12, 1
    s_cmp_lt_i32 s12, 0
    s_cbranch_scc1 L_s21_ok
    s_sleep 4
    buffer_load_dwordx4 v[228:231], v239, s[52:55], s94 offen sc1
    s_waitcnt vmcnt(0)
    s_branch L_s21_chk
L_s21_ok:
    v_lshlrev_b32 v184, 16, v228
    v_and_b32 v186, 0xffff0000, v228
    v_lshlrev_b32_e64 v188, 16, v230
    v_and_b32 v190, 0xffff0000, v230
    v_rcp_f32 v184, v184
    v_rcp_f32 v188, v188
    ds_read_b128 v[152:155], v233 offset:384
    ds_read_b128 v[156:159], v233 offset:448
    ds_read_b128 v[160:163], v233 offset:512
    ds_read_b128 v[164:167], v233 offset:576
    ds_read_b128 v[168:171], v233 offset:640
    ds_read_b128 v[172:175], v233 offset:704
    ds_read_b128 v[176:179], v233 offset:768
    ds_read_b128 v[180:183], v233 offset:832
    s_mul_i32 s6, s77, 232960
    s_add_u32 s6, s6, s79
    s_add_u32 s6, s6, 0xd01000
    v_mul_f32 v185, 0xbfb8aa3b, v184
    v_mul_f32 v186, -v186, v184
    v_mul_f32 v189, 0xbfb8aa3b, v188
    v_mul_f32 v190, -v190, v188
    s_waitcnt lgkmcnt(8)
    v_pk_fma_f32 v[200:201], v[128:129], v[186:187], v[132:133] op_sel:[0,0,0] op_sel_hi:[1,0,1]
    v_pk_fma_f32 v[204:205], v[128:129], v[190:191], v[132:133] op_sel:[0,0,0] op_sel_hi:[1,0,1]
    v_pk_fma_f32 v[208:209], v[136:137], v[186:187], v[140:141] op_sel:[0,0,0] op_sel_hi:[1,0,1]
    v_pk_fma_f32 v[212:213], v[136:137], v[190:191], v[140:141] op_sel:[0,0,0] op_sel_hi:[1,0,1]
    v_pk_fma_f32 v[202:203], v[130:131], v[186:187], v[134:135] op_sel:[0,0,0] op_sel_hi:[1,0,1]
    v_pk_fma_f32 v[206:207], v[130:131], v[190:191], v[134:135] op_sel:[0,0,0] op_sel_hi:[1,0,1]
    v_pk_fma_f32 v[210:211], v[138:139], v[186:187], v[142:143] op_sel:[0,0,0] op_sel_hi:[1,0,1]
    v_pk_fma_f32 v[214:215], v[138:139], v[190:191], v[142:143] op_sel:[0,0,0] op_sel_hi:[1,0,1]
    v_pk_fma_f32 v[200:201], v[16:17], v[184:185], v[200:201] op_sel:[0,1,0] op_sel_hi:[1,1,1]
    v_pk_fma_f32 v[204:205], v[20:21], v[188:189], v[204:205] op_sel:[0,1,0] op_sel_hi:[1,1,1]
    v_pk_fma_f32 v[208:209], v[24:25], v[184:185], v[208:209] op_sel:[0,1,0] op_sel_hi:[1,1,1]
    v_pk_fma_f32 v[212:213], v[28:29], v[188:189], v[212:213] op_sel:[0,1,0] op_sel_hi:[1,1,1]
    v_exp_f32 v200, v200
    v_exp_f32 v201, v201
    v_exp_f32 v204, v204
    v_exp_f32 v205, v205
    v_exp_f32 v208, v208
    v_exp_f32 v209, v209
    v_exp_f32 v212, v212
    v_exp_f32 v213, v213
    v_pk_fma_f32 v[202:203], v[18:19], v[184:185], v[202:203] op_sel:[0,0,0] op_sel_hi:[1,0,1]
    v_pk_fma_f32 v[206:207], v[22:23], v[188:189], v[206:207] op_sel:[0,0,0] op_sel_hi:[1,0,1]
    v_pk_fma_f32 v[210:211], v[26:27], v[184:185], v[210:211] op_sel:[0,0,0] op_sel_hi:[1,0,1]
    v_pk_fma_f32 v[214:215], v[30:31], v[188:189], v[214:215] op_sel:[0,0,0] op_sel_hi:[1,0,1]
    v_pk_add_f32 v[200:201], v[200:201], 1.0 op_sel_hi:[1,0]
    v_pk_add_f32 v[204:205], v[204:205], 1.0 op_sel_hi:[1,0]
    v_pk_add_f32 v[208:209], v[208:209], 1.0 op_sel_hi:[1,0]
    v_pk_add_f32 v[212:213], v[212:213], 1.0 op_sel_hi:[1,0]
    v_rcp_f32 v200, v200
    v_rcp_f32 v201, v201
    v_rcp_f32 v204, v204
    v_rcp_f32 v205, v205
    v_rcp_f32 v208, v208
    v_rcp_f32 v209, v209
    v_rcp_f32 v212, v212
    v_rcp_f32 v213, v213
    v_pk_mul_f32 v[200:201], v[200:201], v[202:203]
    v_pk_mul_f32 v[204:205], v[204:205], v[206:207]
    v_pk_mul_f32 v[208:209], v[208:209], v[210:211]
    v_pk_mul_f32 v[212:213], v[212:213], v[214:215]
    v_cvt_pk_bf16_f32 v224, v200, v201
    v_cvt_pk_bf16_f32 v225, v204, v205
    v_cvt_pk_bf16_f32 v226, v208, v209
    v_cvt_pk_bf16_f32 v227, v212, v213
    buffer_store_dwordx2 v[224:225], v232, s[52:55], s6 offen sc1
    s_add_u32 s6, s6, 33280
    buffer_store_dwordx2 v[226:227], v232, s[52:55], s6 offen sc1
    s_add_u32 s6, s6, 33280
    s_waitcnt lgkmcnt(6)
    s_nop 0
    v_pk_fma_f32 v[200:201], v[144:145], v[186:187], v[148:149] op_sel:[0,0,0] op_sel_hi:[1,0,1]
    v_pk_fma_f32 v[204:205], v[144:145], v[190:191], v[148:149] op_sel:[0,0,0] op_sel_hi:[1,0,1]
    v_pk_fma_f32 v[208:209], v[152:153], v[186:187], v[156:157] op_sel:[0,0,0] op_sel_hi:[1,0,1]
    v_pk_fma_f32 v[212:213], v[152:153], v[190:191], v[156:157] op_sel:[0,0,0] op_sel_hi:[1,0,1]
    v_pk_fma_f32 v[202:203], v[146:147], v[186:187], v[150:151] op_sel:[0,0,0] op_sel_hi:[1,0,1]
    v_pk_fma_f32 v[206:207], v[146:147], v[190:191], v[150:151] op_sel:[0,0,0] op_sel_hi:[1,0,1]
    v_pk_fma_f32 v[210:211], v[154:155], v[186:187], v[158:159] op_sel:[0,0,0] op_sel_hi:[1,0,1]
    v_pk_fma_f32 v[214:215], v[154:155], v[190:191], v[158:159] op_sel:[0,0,0] op_sel_hi:[1,0,1]
    v_pk_fma_f32 v[200:201], v[32:33], v[184:185], v[200:201] op_sel:[0,1,0] op_sel_hi:[1,1,1]
    v_pk_fma_f32 v[204:205], v[36:37], v[188:189], v[204:205] op_sel:[0,1,0] op_sel_hi:[1,1,1]
    v_pk_fma_f32 v[208:209], v[40:41], v[184:185], v[208:209] op_sel:[0,1,0] op_sel_hi:[1,1,1]
    v_pk_fma_f32 v[212:213], v[44:45], v[188:189], v[212:213] op_sel:[0,1,0] op_sel_hi:[1,1,1]
    v_exp_f32 v200, v200
    v_exp_f32 v201, v201
    v_exp_f32 v204, v204
    v_exp_f32 v205, v205
    v_exp_f32 v208, v208
    v_exp_f32 v209, v209
    v_exp_f32 v212, v212
    v_exp_f32 v213, v213
    v_pk_fma_f32 v[202:203], v[34:35], v[184:185], v[202:203] op_sel:[0,0,0] op_sel_hi:[1,0,1]
    v_pk_fma_f32 v[206:207], v[38:39], v[188:189], v[206:207] op_sel:[0,0,0] op_sel_hi:[1,0,1]
    v_pk_fma_f32 v[210:211], v[42:43], v[184:185], v[210:211] op_sel:[0,0,0] op_sel_hi:[1,0,1]
    v_pk_fma_f32 v[214:215], v[46:47], v[188:189], v[214:215] op_sel:[0,0,0] op_sel_hi:[1,0,1]
    v_pk_add_f32 v[200:201], v[200:201], 1.0 op_sel_hi:[1,0]
    v_pk_add_f32 v[204:205], v[204:205], 1.0 op_sel_hi:[1,0]
    v_pk_add_f32 v[208:209], v[208:209], 1.0 op_sel_hi:[1,0]
    v_pk_add_f32 v[212:213], v[212:213], 1.0 op_sel_hi:[1,0]
    v_rcp_f32 v200, v200
    v_rcp_f32 v201, v201
    v_rcp_f32 v204, v204
    v_rcp_f32 v205, v205
    v_rcp_f32 v208, v208
    v_rcp_f32 v209, v209
    v_rcp_f32 v212, v212
    v_rcp_f32 v213, v213
    v_pk_mul_f32 v[200:201], v[200:201], v[202:203]
    v_pk_mul_f32 v[204:205], v[204:205], v[206:207]
    v_pk_mul_f32 v[208:209], v[208:209], v[210:211]
    v_pk_mul_f32 v[212:213], v[212:213], v[214:215]
    v_cvt_pk_bf16_f32 v224, v200, v201
    v_cvt_pk_bf16_f32 v225, v204, v205
    v_cvt_pk_bf16_f32 v226, v208, v209
    v_cvt_pk_bf16_f32 v227, v212, v213
    buffer_store_dwordx2 v[224:225], v232, s[52:55], s6 offen sc1
    s_add_u32 s6, s6, 33280
    buffer_store_dwordx2 v[226:227], v232, s[52:55], s6 offen sc1
    s_add_u32 s6, s6, 33280
    s_waitcnt lgkmcnt(2)
    s_nop 0
    v_pk_fma_f32 v[200:201], v[160:161], v[186:187], v[164:165] op_sel:[0,0,0] op_sel_hi:[1,0,1]
    v_pk_fma_f32 v[204:205], v[160:161], v[190:191], v[164:165] op_sel:[0,0,0] op_sel_hi:[1,0,1]
    v_pk_fma_f32 v[208:209], v[168:169], v[186:187], v[172:173] op_sel:[0,0,0] op_sel_hi:[1,0,1]
    v_pk_fma_f32 v[212:213], v[168:169], v[190:191], v[172:173] op_sel:[0,0,0] op_sel_hi:[1,0,1]
    v_pk_fma_f32 v[202:203], v[162:163], v[186:187], v[166:167] op_sel:[0,0,0] op_sel_hi:[1,0,1]
    v_pk_fma_f32 v[206:207], v[162:163], v[190:191], v[166:167] op_sel:[0,0,0] op_sel_hi:[1,0,1]
    v_pk_fma_f32 v[210:211], v[170:171], v[186:187], v[174:175] op_sel:[0,0,0] op_sel_hi:[1,0,1]
    v_pk_fma_f32 v[214:215], v[170:171], v[190:191], v[174:175] op_sel:[0,0,0] op_sel_hi:[1,0,1]
    v_pk_fma_f32 v[200:201], v[48:49], v[184:185], v[200:201] op_sel:[0,1,0] op_sel_hi:[1,1,1]
    v_pk_fma_f32 v[204:205], v[52:53], v[188:189], v[204:205] op_sel:[0,1,0] op_sel_hi:[1,1,1]
    v_pk_fma_f32 v[208:209], v[56:57], v[184:185], v[208:209] op_sel:[0,1,0] op_sel_hi:[1,1,1]
    v_pk_fma_f32 v[212:213], v[60:61], v[188:189], v[212:213] op_sel:[0,1,0] op_sel_hi:[1,1,1]
    v_exp_f32 v200, v200
    v_exp_f32 v201, v201
    v_exp_f32 v204, v204
    v_exp_f32 v205, v205
    v_exp_f32 v208, v208
    v_exp_f32 v209, v209
    v_exp_f32 v212, v212
    v_exp_f32 v213, v213
    v_pk_fma_f32 v[202:203], v[50:51], v[184:185], v[202:203] op_sel:[0,0,0] op_sel_hi:[1,0,1]
    v_pk_fma_f32 v[206:207], v[54:55], v[188:189], v[206:207] op_sel:[0,0,0] op_sel_hi:[1,0,1]
    v_pk_fma_f32 v[210:211], v[58:59], v[184:185], v[210:211] op_sel:[0,0,0] op_sel_hi:[1,0,1]
    v_pk_fma_f32 v[214:215], v[62:63], v[188:189], v[214:215] op_sel:[0,0,0] op_sel_hi:[1,0,1]
    v_pk_add_f32 v[200:201], v[200:201], 1.0 op_sel_hi:[1,0]
    v_pk_add_f32 v[204:205], v[204:205], 1.0 op_sel_hi:[1,0]
    v_pk_add_f32 v[208:209], v[208:209], 1.0 op_sel_hi:[1,0]
    v_pk_add_f32 v[212:213], v[212:213], 1.0 op_sel_hi:[1,0]
    v_rcp_f32 v200, v200
    v_rcp_f32 v201, v201
    v_rcp_f32 v204, v204
    v_rcp_f32 v205, v205
    v_rcp_f32 v208, v208
    v_rcp_f32 v209, v209
    v_rcp_f32 v212, v212
    v_rcp_f32 v213, v213
    v_pk_mul_f32 v[200:201], v[200:201], v[202:203]
    v_pk_mul_f32 v[204:205], v[204:205], v[206:207]
    v_pk_mul_f32 v[208:209], v[208:209], v[210:211]
    v_pk_mul_f32 v[212:213], v[212:213], v[214:215]
    v_cvt_pk_bf16_f32 v224, v200, v201
    v_cvt_pk_bf16_f32 v225, v204, v205
    v_cvt_pk_bf16_f32 v226, v208, v209
    v_cvt_pk_bf16_f32 v227, v212, v213
    buffer_store_dwordx2 v[224:225], v232, s[52:55], s6 offen sc1
    s_add_u32 s6, s6, 33280
    buffer_store_dwordx2 v[226:227], v232, s[52:55], s6 offen sc1
    s_add_u32 s6, s6, 33280
    s_waitcnt lgkmcnt(0)
    s_nop 0
    v_pk_fma_f32 v[200:201], v[176:177], v[186:187], v[180:181] op_sel:[0,0,0] op_sel_hi:[1,0,1]
    v_pk_fma_f32 v[204:205], v[176:177], v[190:191], v[180:181] op_sel:[0,0,0] op_sel_hi:[1,0,1]
    v_pk_fma_f32 v[202:203], v[178:179], v[186:187], v[182:183] op_sel:[0,0,0] op_sel_hi:[1,0,1]
    v_pk_fma_f32 v[206:207], v[178:179], v[190:191], v[182:183] op_sel:[0,0,0] op_sel_hi:[1,0,1]
    v_pk_fma_f32 v[200:201], v[64:65], v[184:185], v[200:201] op_sel:[0,1,0] op_sel_hi:[1,1,1]
    v_pk_fma_f32 v[204:205], v[68:69], v[188:189], v[204:205] op_sel:[0,1,0] op_sel_hi:[1,1,1]
    v_exp_f32 v200, v200
    v_exp_f32 v201, v201
    v_exp_f32 v204, v204
    v_exp_f32 v205, v205
    v_pk_fma_f32 v[202:203], v[66:67], v[184:185], v[202:203] op_sel:[0,0,0] op_sel_hi:[1,0,1]
    v_pk_fma_f32 v[206:207], v[70:71], v[188:189], v[206:207] op_sel:[0,0,0] op_sel_hi:[1,0,1]
    v_pk_add_f32 v[200:201], v[200:201], 1.0 op_sel_hi:[1,0]
    v_pk_add_f32 v[204:205], v[204:205], 1.0 op_sel_hi:[1,0]
    v_rcp_f32 v200, v200
    v_rcp_f32 v201, v201
    v_rcp_f32 v204, v204
    v_rcp_f32 v205, v205
    v_pk_mul_f32 v[200:201], v[200:201], v[202:203]
    v_pk_mul_f32 v[204:205], v[204:205], v[206:207]
    v_cvt_pk_bf16_f32 v224, v200, v201
    v_cvt_pk_bf16_f32 v225, v204, v205
    buffer_store_dwordx2 v[224:225], v232, s[52:55], s6 offen sc1
    s_waitcnt vmcnt(19)
    s_mov_b64 vcc, s[42:43]
    v_cndmask_b32_dpp v184, v106, v104, vcc row_ror:8 row_mask:0xf bank_mask:0xf
    v_cndmask_b32_dpp v185, v110, v108, vcc row_ror:8 row_mask:0xf bank_mask:0xf
    v_cndmask_b32_dpp v188, v107, v105, vcc row_ror:8 row_mask:0xf bank_mask:0xf
    v_cndmask_b32_dpp v189, v111, v109, vcc row_ror:8 row_mask:0xf bank_mask:0xf
    s_mov_b64 vcc, s[44:45]
    v_cndmask_b32_dpp v186, v104, v106, vcc row_ror:8 row_mask:0xf bank_mask:0xf
    v_cndmask_b32_dpp v187, v108, v110, vcc row_ror:8 row_mask:0xf bank_mask:0xf
    v_cndmask_b32_dpp v190, v105, v107, vcc row_ror:8 row_mask:0xf bank_mask:0xf
    v_cndmask_b32_dpp v191, v109, v111, vcc row_ror:8 row_mask:0xf bank_mask:0xf
    v_mfma_f32_16x16x32_bf16 v[16:19], a[0:3], v[184:187], 0
    buffer_load_dwordx4 v[104:107], v244, s[52:55], s23 offen sc1
    v_mfma_f32_16x16x32_bf16 v[20:23], a[4:7], v[184:187], 0
    buffer_load_dwordx4 v[108:111], v245, s[52:55], s23 offen sc1
    v_mfma_f32_16x16x32_bf16 v[24:27], a[8:11], v[184:187], 0
    s_waitcnt vmcnt(19)
    v_cndmask_b32_dpp v194, v112, v114, vcc row_ror:8 row_mask:0xf bank_mask:0xf
    v_mfma_f32_16x16x32_bf16 v[28:31], a[12:15], v[184:187], 0
    v_cndmask_b32_dpp v195, v116, v118, vcc row_ror:8 row_mask:0xf bank_mask:0xf
    v_cndmask_b32_dpp v198, v113, v115, vcc row_ror:8 row_mask:0xf bank_mask:0xf
    v_mfma_f32_16x16x32_bf16 v[32:35], a[0:3], v[188:191], 0
    v_cndmask_b32_dpp v199, v117, v119, vcc row_ror:8 row_mask:0xf bank_mask:0xf
    s_mov_b64 vcc, s[42:43]
    v_mfma_f32_16x16x32_bf16 v[36:39], a[4:7], v[188:191], 0
    v_cndmask_b32_dpp v192, v114, v112, vcc row_ror:8 row_mask:0xf bank_mask:0xf
    v_cndmask_b32_dpp v193, v118, v116, vcc row_ror:8 row_mask:0xf bank_mask:0xf
    v_mfma_f32_16x16x32_bf16 v[40:43], a[8:11], v[188:191], 0
    v_cndmask_b32_dpp v196, v115, v113, vcc row_ror:8 row_mask:0xf bank_mask:0xf
    v_cndmask_b32_dpp v197, v119, v117, vcc row_ror:8 row_mask:0xf bank_mask:0xf
    v_mfma_f32_16x16x32_bf16 v[44:47], a[12:15], v[188:191], 0
    v_mfma_f32_16x16x32_bf16 v[16:19], a[16:19], v[192:195], v[16:19]
    buffer_load_dwordx4 v[112:115], v244, s[52:55], s24 offen sc1
    v_mfma_f32_16x16x32_bf16 v[20:23], a[20:23], v[192:195], v[20:23]
    buffer_load_dwordx4 v[116:119], v245, s[52:55], s24 offen sc1
    v_mfma_f32_16x16x32_bf16 v[24:27], a[24:27], v[192:195], v[24:27]
    s_waitcnt vmcnt(19)
    v_cndmask_b32_dpp v184, v122, v120, vcc row_ror:8 row_mask:0xf bank_mask:0xf
    v_mfma_f32_16x16x32_bf16 v[28:31], a[28:31], v[192:195], v[28:31]
    v_cndmask_b32_dpp v185, v126, v124, vcc row_ror:8 row_mask:0xf bank_mask:0xf
    v_cndmask_b32_dpp v188, v123, v121, vcc row_ror:8 row_mask:0xf bank_mask:0xf
    v_mfma_f32_16x16x32_bf16 v[32:35], a[16:19], v[196:199], v[32:35]
    v_cndmask_b32_dpp v189, v127, v125, vcc row_ror:8 row_mask:0xf bank_mask:0xf
    s_mov_b64 vcc, s[44:45]
    v_mfma_f32_16x16x32_bf16 v[36:39], a[20:23], v[196:199], v[36:39]
    v_cndmask_b32_dpp v186, v120, v122, vcc row_ror:8 row_mask:0xf bank_mask:0xf
    v_cndmask_b32_dpp v187, v124, v126, vcc row_ror:8 row_mask:0xf bank_mask:0xf
    v_mfma_f32_16x16x32_bf16 v[40:43], a[24:27], v[196:199], v[40:43]
    v_cndmask_b32_dpp v190, v121, v123, vcc row_ror:8 row_mask:0xf bank_mask:0xf
    v_cndmask_b32_dpp v191, v125, v127, vcc row_ror:8 row_mask:0xf bank_mask:0xf
    v_mfma_f32_16x16x32_bf16 v[44:47], a[28:31], v[196:199], v[44:47]
    v_mfma_f32_16x16x32_bf16 v[16:19], a[32:35], v[184:187], v[16:19]
    buffer_load_dwordx4 v[120:123], v244, s[52:55], s25 offen sc1
    v_mfma_f32_16x16x32_bf16 v[20:23], a[36:39], v[184:187], v[20:23]
    buffer_load_dwordx4 v[124:127], v245, s[52:55], s25 offen sc1
    v_mfma_f32_16x16x32_bf16 v[24:27], a[40:43], v[184:187], v[24:27]
    s_waitcnt vmcnt(19)
    v_cndmask_b32_dpp v194, v72, v74, vcc row_ror:8 row_mask:0xf bank_mask:0xf
    v_mfma_f32_16x16x32_bf16 v[28:31], a[44:47], v[184:187], v[28:31]
    v_cndmask_b32_dpp v195, v76, v78, vcc row_ror:8 row_mask:0xf bank_mask:0xf
    v_cndmask_b32_dpp v198, v73, v75, vcc row_ror:8 row_mask:0xf bank_mask:0xf
    v_mfma_f32_16x16x32_bf16 v[32:35], a[32:35], v[188:191], v[32:35]
    v_cndmask_b32_dpp v199, v77, v79, vcc row_ror:8 row_mask:0xf bank_mask:0xf
    s_mov_b64 vcc, s[42:43]
    v_mfma_f32_16x16x32_bf16 v[36:39], a[36:39], v[188:191], v[36:39]
    v_cndmask_b32_dpp v192, v74, v72, vcc row_ror:8 row_mask:0xf bank_mask:0xf
    v_cndmask_b32_dpp v193, v78, v76, vcc row_ror:8 row_mask:0xf bank_mask:0xf
    v_mfma_f32_16x16x32_bf16 v[40:43], a[40:43], v[188:191], v[40:43]
    v_cndmask_b32_dpp v196, v75, v73, vcc row_ror:8 row_mask:0xf bank_mask:0xf
    v_cndmask_b32_dpp v197, v79, v77, vcc row_ror:8 row_mask:0xf bank_mask:0xf
    v_mfma_f32_16x16x32_bf16 v[44:47], a[44:47], v[188:191], v[44:47]
    v_mfma_f32_16x16x32_bf16 v[16:19], a[48:51], v[192:195], v[16:19]
    buffer_load_dwordx4 v[72:75], v244, s[52:55], s26 offen sc1
    v_mfma_f32_16x16x32_bf16 v[20:23], a[52:55], v[192:195], v[20:23]
    buffer_load_dwordx4 v[76:79], v245, s[52:55], s26 offen sc1
    v_mfma_f32_16x16x32_bf16 v[24:27], a[56:59], v[192:195], v[24:27]
    s_waitcnt vmcnt(19)
    v_cndmask_b32_dpp v184, v82, v80, vcc row_ror:8 row_mask:0xf bank_mask:0xf
    v_mfma_f32_16x16x32_bf16 v[28:31], a[60:63], v[192:195], v[28:31]
    v_cndmask_b32_dpp v185, v86, v84, vcc row_ror:8 row_mask:0xf bank_mask:0xf
    v_cndmask_b32_dpp v188, v83, v81, vcc row_ror:8 row_mask:0xf bank_mask:0xf
    v_mfma_f32_16x16x32_bf16 v[32:35], a[48:51], v[196:199], v[32:35]
    v_cndmask_b32_dpp v189, v87, v85, vcc row_ror:8 row_mask:0xf bank_mask:0xf
    s_mov_b64 vcc, s[44:45]
    v_mfma_f32_16x16x32_bf16 v[36:39], a[52:55], v[196:199], v[36:39]
    v_cndmask_b32_dpp v186, v80, v82, vcc row_ror:8 row_mask:0xf bank_mask:0xf
    v_cndmask_b32_dpp v187, v84, v86, vcc row_ror:8 row_mask:0xf bank_mask:0xf
    v_mfma_f32_16x16x32_bf16 v[40:43], a[56:59], v[196:199], v[40:43]
    v_cndmask_b32_dpp v190, v81, v83, vcc row_ror:8 row_mask:0xf bank_mask:0xf
    v_cndmask_b32_dpp v191, v85, v87, vcc row_ror:8 row_mask:0xf bank_mask:0xf
    v_mfma_f32_16x16x32_bf16 v[44:47], a[60:63], v[196:199], v[44:47]
    v_mfma_f32_16x16x32_bf16 v[16:19], a[64:67], v[184:187], v[16:19]
    buffer_load_dwordx4 v[80:83], v244, s[52:55], s27 offen sc1
    v_mfma_f32_16x16x32_bf16 v[20:23], a[68:71], v[184:187], v[20:23]
    buffer_load_dwordx4 v[84:87], v245, s[52:55], s27 offen sc1
    v_mfma_f32_16x16x32_bf16 v[24:27], a[72:75], v[184:187], v[24:27]
    s_waitcnt vmcnt(19)
    v_cndmask_b32_dpp v194, v88, v90, vcc row_ror:8 row_mask:0xf bank_mask:0xf
    v_mfma_f32_16x16x32_bf16 v[28:31], a[76:79], v[184:187], v[28:31]
    v_cndmask_b32_dpp v195, v92, v94, vcc row_ror:8 row_mask:0xf bank_mask:0xf
    v_cndmask_b32_dpp v198, v89, v91, vcc row_ror:8 row_mask:0xf bank_mask:0xf
    v_mfma_f32_16x16x32_bf16 v[32:35], a[64:67], v[188:191], v[32:35]
    v_cndmask_b32_dpp v199, v93, v95, vcc row_ror:8 row_mask:0xf bank_mask:0xf
    s_mov_b64 vcc, s[42:43]
    v_mfma_f32_16x16x32_bf16 v[36:39], a[68:71], v[188:191], v[36:39]
    v_cndmask_b32_dpp v192, v90, v88, vcc row_ror:8 row_mask:0xf bank_mask:0xf
    v_cndmask_b32_dpp v193, v94, v92, vcc row_ror:8 row_mask:0xf bank_mask:0xf
    v_mfma_f32_16x16x32_bf16 v[40:43], a[72:75], v[188:191], v[40:43]
    v_cndmask_b32_dpp v196, v91, v89, vcc row_ror:8 row_mask:0xf bank_mask:0xf
    v_cndmask_b32_dpp v197, v95, v93, vcc row_ror:8 row_mask:0xf bank_mask:0xf
    v_mfma_f32_16x16x32_bf16 v[44:47], a[76:79], v[188:191], v[44:47]
    v_mfma_f32_16x16x32_bf16 v[16:19], a[80:83], v[192:195], v[16:19]
    buffer_load_dwordx4 v[88:91], v244, s[52:55], s28 offen sc1
    v_mfma_f32_16x16x32_bf16 v[20:23], a[84:87], v[192:195], v[20:23]
    buffer_load_dwordx4 v[92:95], v245, s[52:55], s28 offen sc1
    v_mfma_f32_16x16x32_bf16 v[24:27], a[88:91], v[192:195], v[24:27]
    s_waitcnt vmcnt(12)
    v_mov_b32 v242, s72
    s_mov_b64 exec, 1
    buffer_store_dword v242, off, s[52:55], s61 offset:0 sc1
    s_mov_b64 exec, -1
    v_cndmask_b32_dpp v184, v98, v96, vcc row_ror:8 row_mask:0xf bank_mask:0xf
    v_mfma_f32_16x16x32_bf16 v[28:31], a[92:95], v[192:195], v[28:31]
    v_cndmask_b32_dpp v185, v102, v100, vcc row_ror:8 row_mask:0xf bank_mask:0xf
    v_cndmask_b32_dpp v188, v99, v97, vcc row_ror:8 row_mask:0xf bank_mask:0xf
    v_mfma_f32_16x16x32_bf16 v[32:35], a[80:83], v[196:199], v[32:35]
    v_cndmask_b32_dpp v189, v103, v101, vcc row_ror:8 row_mask:0xf bank_mask:0xf
    s_mov_b64 vcc, s[44:45]
    v_mfma_f32_16x16x32_bf16 v[36:39], a[84:87], v[196:199], v[36:39]
    v_cndmask_b32_dpp v186, v96, v98, vcc row_ror:8 row_mask:0xf bank_mask:0xf
    v_cndmask_b32_dpp v187, v100, v102, vcc row_ror:8 row_mask:0xf bank_mask:0xf
    v_mfma_f32_16x16x32_bf16 v[40:43], a[88:91], v[196:199], v[40:43]
    v_cndmask_b32_dpp v190, v97, v99, vcc row_ror:8 row_mask:0xf bank_mask:0xf
    v_cndmask_b32_dpp v191, v101, v103, vcc row_ror:8 row_mask:0xf bank_mask:0xf
    v_mfma_f32_16x16x32_bf16 v[44:47], a[92:95], v[196:199], v[44:47]
    v_mfma_f32_16x16x32_bf16 v[16:19], a[96:99], v[184:187], v[16:19]
    buffer_load_dwordx4 v[96:99], v244, s[52:55], s29 offen sc1
    v_mfma_f32_16x16x32_bf16 v[20:23], a[100:103], v[184:187], v[20:23]
    buffer_load_dwordx4 v[100:103], v245, s[52:55], s29 offen sc1
    v_mfma_f32_16x16x32_bf16 v[24:27], a[104:107], v[184:187], v[24:27]
    s_waitcnt vmcnt(13)
    v_cndmask_b32_dpp v194, v104, v106, vcc row_ror:8 row_mask:0xf bank_mask:0xf
    v_mfma_f32_16x16x32_bf16 v[28:31], a[108:111], v[184:187], v[28:31]
    v_cndmask_b32_dpp v195, v108, v110, vcc row_ror:8 row_mask:0xf bank_mask:0xf
    v_cndmask_b32_dpp v198, v105, v107, vcc row_ror:8 row_mask:0xf bank_mask:0xf
    v_mfma_f32_16x16x32_bf16 v[32:35], a[96:99], v[188:191], v[32:35]
    v_cndmask_b32_dpp v199, v109, v111, vcc row_ror:8 row_mask:0xf bank_mask:0xf
    s_mov_b64 vcc, s[42:43]
    v_mfma_f32_16x16x32_bf16 v[36:39], a[100:103], v[188:191], v[36:39]
    v_cndmask_b32_dpp v192, v106, v104, vcc row_ror:8 row_mask:0xf bank_mask:0xf
    v_cndmask_b32_dpp v193, v110, v108, vcc row_ror:8 row_mask:0xf bank_mask:0xf
    v_mfma_f32_16x16x32_bf16 v[40:43], a[104:107], v[188:191], v[40:43]
    v_cndmask_b32_dpp v196, v107, v105, vcc row_ror:8 row_mask:0xf bank_mask:0xf
    v_cndmask_b32_dpp v197, v111, v109, vcc row_ror:8 row_mask:0xf bank_mask:0xf
    v_mfma_f32_16x16x32_bf16 v[44:47], a[108:111], v[188:191], v[44:47]
    v_mfma_f32_16x16x32_bf16 v[16:19], a[112:115], v[192:195], v[16:19]
    buffer_load_dwordx4 v[56:59], v6, s[52:55], s46 offen sc1
    v_mfma_f32_16x16x32_bf16 v[20:23], a[116:119], v[192:195], v[20:23]
    buffer_load_dwordx4 v[60:63], v6, s[52:55], s46 offen offset:16 sc1
    v_mfma_f32_16x16x32_bf16 v[24:27], a[120:123], v[192:195], v[24:27]
    v_add_u32 v244, 0x1000, v244
    v_add_u32 v245, 0x1000, v245
    s_waitcnt vmcnt(13)
    v_cndmask_b32_dpp v184, v114, v112, vcc row_ror:8 row_mask:0xf bank_mask:0xf
    v_mfma_f32_16x16x32_bf16 v[28:31], a[124:127], v[192:195], v[28:31]
    v_cndmask_b32_dpp v185, v118, v116, vcc row_ror:8 row_mask:0xf bank_mask:0xf
    v_cndmask_b32_dpp v188, v115, v113, vcc row_ror:8 row_mask:0xf bank_mask:0xf
    v_mfma_f32_16x16x32_bf16 v[32:35], a[112:115], v[196:199], v[32:35]
    v_cndmask_b32_dpp v189, v119, v117, vcc row_ror:8 row_mask:0xf bank_mask:0xf
    s_mov_b64 vcc, s[44:45]
    v_mfma_f32_16x16x32_bf16 v[36:39], a[116:119], v[196:199], v[36:39]
    v_cndmask_b32_dpp v186, v112, v114, vcc row_ror:8 row_mask:0xf bank_mask:0xf
    v_cndmask_b32_dpp v187, v116, v118, vcc row_ror:8 row_mask:0xf bank_mask:0xf
    v_mfma_f32_16x16x32_bf16 v[40:43], a[120:123], v[196:199], v[40:43]
    v_cndmask_b32_dpp v190, v113, v115, vcc row_ror:8 row_mask:0xf bank_mask:0xf
    v_cndmask_b32_dpp v191, v117, v119, vcc row_ror:8 row_mask:0xf bank_mask:0xf
    v_mfma_f32_16x16x32_bf16 v[44:47], a[124:127], v[196:199], v[44:47]
    v_mfma_f32_16x16x32_bf16 v[16:19], a[128:131], v[184:187], v[16:19]
    v_mfma_f32_16x16x32_bf16 v[20:23], a[132:135], v[184:187], v[20:23]
    v_mfma_f32_16x16x32_bf16 v[24:27], a[136:139], v[184:187], v[24:27]
    s_waitcnt vmcnt(11)
    v_cndmask_b32_dpp v194, v120, v122, vcc row_ror:8 row_mask:0xf bank_mask:0xf
    v_mfma_f32_16x16x32_bf16 v[28:31], a[140:143], v[184:187], v[28:31]
    v_cndmask_b32_dpp v195, v124, v126, vcc row_ror:8 row_mask:0xf bank_mask:0xf
    v_cndmask_b32_dpp v198, v121, v123, vcc row_ror:8 row_mask:0xf bank_mask:0xf
    v_mfma_f32_16x16x32_bf16 v[32:35], a[128:131], v[188:191], v[32:35]
    v_cndmask_b32_dpp v199, v125, v127, vcc row_ror:8 row_mask:0xf bank_mask:0xf
    s_mov_b64 vcc, s[42:43]
    v_mfma_f32_16x16x32_bf16 v[36:39], a[132:135], v[188:191], v[36:39]
    v_cndmask_b32_dpp v192, v122, v120, vcc row_ror:8 row_mask:0xf bank_mask:0xf
    v_cndmask_b32_dpp v193, v126, v124, vcc row_ror:8 row_mask:0xf bank_mask:0xf
    v_mfma_f32_16x16x32_bf16 v[40:43], a[136:139], v[188:191], v[40:43]
    v_cndmask_b32_dpp v196, v123, v121, vcc row_ror:8 row_mask:0xf bank_mask:0xf
    v_cndmask_b32_dpp v197, v127, v125, vcc row_ror:8 row_mask:0xf bank_mask:0xf
    v_mfma_f32_16x16x32_bf16 v[44:47], a[140:143], v[188:191], v[44:47]
    v_mfma_f32_16x16x32_bf16 v[16:19], a[144:147], v[192:195], v[16:19]
    buffer_load_dword v48, v5, s[52:55], s47 offen offset:0 sc1
    v_mfma_f32_16x16x32_bf16 v[20:23], a[148:151], v[192:195], v[20:23]
    buffer_load_dword v49, v5, s[52:55], s47 offen offset:64 sc1
    v_mfma_f32_16x16x32_bf16 v[24:27], a[152:155], v[192:195], v[24:27]
    s_waitcnt vmcnt(11)
    v_cndmask_b32_dpp v184, v74, v72, vcc row_ror:8 row_mask:0xf bank_mask:0xf
    v_mfma_f32_16x16x32_bf16 v[28:31], a[156:159], v[192:195], v[28:31]
    v_cndmask_b32_dpp v185, v78, v76, vcc row_ror:8 row_mask:0xf bank_mask:0xf
    v_cndmask_b32_dpp v188, v75, v73, vcc row_ror:8 row_mask:0xf bank_mask:0xf
    v_mfma_f32_16x16x32_bf16 v[32:35], a[144:147], v[196:199], v[32:35]
    v_cndmask_b32_dpp v189, v79, v77, vcc row_ror:8 row_mask:0xf bank_mask:0xf
    s_mov_b64 vcc, s[44:45]
    v_mfma_f32_16x16x32_bf16 v[36:39], a[148:151], v[196:199], v[36:39]
    v_cndmask_b32_dpp v186, v72, v74, vcc row_ror:8 row_mask:0xf bank_mask:0xf
    v_cndmask_b32_dpp v187, v76, v78, vcc row_ror:8 row_mask:0xf bank_mask:0xf
    v_mfma_f32_16x16x32_bf16 v[40:43], a[152:155], v[196:199], v[40:43]
    v_cndmask_b32_dpp v190, v73, v75, vcc row_ror:8 row_mask:0xf bank_mask:0xf
    v_cndmask_b32_dpp v191, v77, v79, vcc row_ror:8 row_mask:0xf bank_mask:0xf
    v_mfma_f32_16x16x32_bf16 v[44:47], a[156:159], v[196:199], v[44:47]
    v_mfma_f32_16x16x32_bf16 v[16:19], a[160:163], v[184:187], v[16:19]
    buffer_load_dword v50, v5, s[52:55], s47 offen offset:128 sc1
    v_mfma_f32_16x16x32_bf16 v[20:23], a[164:167], v[184:187], v[20:23]
    buffer_load_dword v51, v5, s[52:55], s47 offen offset:192 sc1
    v_mfma_f32_16x16x32_bf16 v[24:27], a[168:171], v[184:187], v[24:27]
    s_waitcnt vmcnt(11)
    v_cndmask_b32_dpp v194, v80, v82, vcc row_ror:8 row_mask:0xf bank_mask:0xf
    v_mfma_f32_16x16x32_bf16 v[28:31], a[172:175], v[184:187], v[28:31]
    v_cndmask_b32_dpp v195, v84, v86, vcc row_ror:8 row_mask:0xf bank_mask:0xf
    v_cndmask_b32_dpp v198, v81, v83, vcc row_ror:8 row_mask:0xf bank_mask:0xf
    v_mfma_f32_16x16x32_bf16 v[32:35], a[160:163], v[188:191], v[32:35]
    v_cndmask_b32_dpp v199, v85, v87, vcc row_ror:8 row_mask:0xf bank_mask:0xf
    s_mov_b64 vcc, s[42:43]
    v_mfma_f32_16x16x32_bf16 v[36:39], a[164:167], v[188:191], v[36:39]
    v_cndmask_b32_dpp v192, v82, v80, vcc row_ror:8 row_mask:0xf bank_mask:0xf
    v_cndmask_b32_dpp v193, v86, v84, vcc row_ror:8 row_mask:0xf bank_mask:0xf
    v_mfma_f32_16x16x32_bf16 v[40:43], a[168:171], v[188:191], v[40:43]
    v_cndmask_b32_dpp v196, v83, v81, vcc row_ror:8 row_mask:0xf bank_mask:0xf
    v_cndmask_b32_dpp v197, v87, v85, vcc row_ror:8 row_mask:0xf bank_mask:0xf
    v_mfma_f32_16x16x32_bf16 v[44:47], a[172:175], v[188:191], v[44:47]
    v_mfma_f32_16x16x32_bf16 v[16:19], a[176:179], v[192:195], v[16:19]
    s_add_u32 s47, s47, 1064960
    buffer_load_dword v52, v5, s[52:55], s47 offen offset:0 sc1
    v_mfma_f32_16x16x32_bf16 v[20:23], a[180:183], v[192:195], v[20:23]
    buffer_load_dword v53, v5, s[52:55], s47 offen offset:64 sc1
    v_mfma_f32_16x16x32_bf16 v[24:27], a[184:187], v[192:195], v[24:27]
    s_waitcnt vmcnt(11)
    v_cndmask_b32_dpp v184, v90, v88, vcc row_ror:8 row_mask:0xf bank_mask:0xf
    v_mfma_f32_16x16x32_bf16 v[28:31], a[188:191], v[192:195], v[28:31]
    v_cndmask_b32_dpp v185, v94, v92, vcc row_ror:8 row_mask:0xf bank_mask:0xf
    v_cndmask_b32_dpp v188, v91, v89, vcc row_ror:8 row_mask:0xf bank_mask:0xf
    v_mfma_f32_16x16x32_bf16 v[32:35], a[176:179], v[196:199], v[32:35]
    v_cndmask_b32_dpp v189, v95, v93, vcc row_ror:8 row_mask:0xf bank_mask:0xf
    s_mov_b64 vcc, s[44:45]
    v_mfma_f32_16x16x32_bf16 v[36:39], a[180:183], v[196:199], v[36:39]
    v_cndmask_b32_dpp v186, v88, v90, vcc row_ror:8 row_mask:0xf bank_mask:0xf
    v_cndmask_b32_dpp v187, v92, v94, vcc row_ror:8 row_mask:0xf bank_mask:0xf
    v_mfma_f32_16x16x32_bf16 v[40:43], a[184:187], v[196:199], v[40:43]
    v_cndmask_b32_dpp v190, v89, v91, vcc row_ror:8 row_mask:0xf bank_mask:0xf
    v_cndmask_b32_dpp v191, v93, v95, vcc row_ror:8 row_mask:0xf bank_mask:0xf
    v_mfma_f32_16x16x32_bf16 v[44:47], a[188:191], v[196:199], v[44:47]
    v_mfma_f32_16x16x32_bf16 v[16:19], a[192:195], v[184:187], v[16:19]
    buffer_load_dword v54, v5, s[52:55], s47 offen offset:128 sc1
    v_mfma_f32_16x16x32_bf16 v[20:23], a[196:199], v[184:187], v[20:23]
    buffer_load_dword v55, v5, s[52:55], s47 offen offset:192 sc1
    v_mfma_f32_16x16x32_bf16 v[24:27], a[200:203], v[184:187], v[24:27]
    s_waitcnt vmcnt(10)
    v_cndmask_b32_dpp v194, v96, v98, vcc row_ror:8 row_mask:0xf bank_mask:0xf
    v_mfma_f32_16x16x32_bf16 v[28:31], a[204:207], v[184:187], v[28:31]
    v_cndmask_b32_dpp v195, v100, v102, vcc row_ror:8 row_mask:0xf bank_mask:0xf
    v_cndmask_b32_dpp v198, v97, v99, vcc row_ror:8 row_mask:0xf bank_mask:0xf
    v_mfma_f32_16x16x32_bf16 v[32:35], a[192:195], v[188:191], v[32:35]
    v_cndmask_b32_dpp v199, v101, v103, vcc row_ror:8 row_mask:0xf bank_mask:0xf
    s_mov_b64 vcc, s[42:43]
    v_mfma_f32_16x16x32_bf16 v[36:39], a[196:199], v[188:191], v[36:39]
    v_cndmask_b32_dpp v192, v98, v96, vcc row_ror:8 row_mask:0xf bank_mask:0xf
    v_cndmask_b32_dpp v193, v102, v100, vcc row_ror:8 row_mask:0xf bank_mask:0xf
    v_mfma_f32_16x16x32_bf16 v[40:43], a[200:203], v[188:191], v[40:43]
    v_cndmask_b32_dpp v196, v99, v97, vcc row_ror:8 row_mask:0xf bank_mask:0xf
    v_cndmask_b32_dpp v197, v103, v101, vcc row_ror:8 row_mask:0xf bank_mask:0xf
    v_mfma_f32_16x16x32_bf16 v[44:47], a[204:207], v[188:191], v[44:47]
    v_mfma_f32_16x16x32_bf16 v[16:19], a[208:211], v[192:195], v[16:19]
    v_mfma_f32_16x16x32_bf16 v[20:23], a[212:215], v[192:195], v[20:23]
    v_mfma_f32_16x16x32_bf16 v[24:27], a[216:219], v[192:195], v[24:27]
    v_mfma_f32_16x16x32_bf16 v[28:31], a[220:223], v[192:195], v[28:31]
    v_mfma_f32_16x16x32_bf16 v[32:35], a[208:211], v[196:199], v[32:35]
    v_mfma_f32_16x16x32_bf16 v[36:39], a[212:215], v[196:199], v[36:39]
    v_mfma_f32_16x16x32_bf16 v[40:43], a[216:219], v[196:199], v[40:43]
    v_mfma_f32_16x16x32_bf16 v[44:47], a[220:223], v[196:199], v[44:47]
    s_cmp_lg_u32 s3, 0
    s_cbranch_scc1 L_hb_np
    buffer_load_dwordx4 v[200:203], v240, s[52:55], s93 offen sc1
L_hb_np:
    ds_write_b128 v3, v[16:19] offset:0
    ds_write_b128 v3, v[20:23] offset:1024
    ds_write_b128 v3, v[24:27] offset:2048
    ds_write_b128 v3, v[28:31] offset:3072
    ds_write_b128 v3, v[32:35] offset:16384
    ds_write_b128 v3, v[36:39] offset:17408
    ds_write_b128 v3, v[40:43] offset:18432
    ds_write_b128 v3, v[44:47] offset:19456
    s_cmp_lg_u32 s3, 0
    s_cbranch_scc1 L_hb_ok
    s_waitcnt vmcnt(0)
L_hb_chk:
    v_min3_u32 v242, v200, v201, s72
    v_max3_u32 v243, v200, v201, s72
    v_min3_u32 v242, v202, v203, v242
    v_max3_u32 v243, v202, v203, v243
    v_cmp_ne_u32 vcc, v242, v243
    s_cbranch_vccz L_hb_ok
    s_sub_u32 s12, s12, 1
    s_cmp_lt_i32 s12, 0
    s_cbranch_scc1 L_hb_ok
    s_sleep 4
    buffer_load_dwordx4 v[200:203], v240, s[52:55], s93 offen sc1
    s_waitcnt vmcnt(0)
    s_branch L_hb_chk
L_hb_ok:
    s_waitcnt lgkmcnt(0)
    s_barrier
    s_nop 0
    buffer_load_dwordx4 v[104:107], v244, s[52:55], s16 offen sc1
    buffer_load_dwordx4 v[108:111], v245, s[52:55], s16 offen sc1
    buffer_load_dwordx4 v[112:115], v244, s[52:55], s17 offen sc1
    buffer_load_dwordx4 v[116:119], v245, s[52:55], s17 offen sc1
    buffer_load_dwordx4 v[120:123], v244, s[52:55], s18 offen sc1
    buffer_load_dwordx4 v[124:127], v245, s[52:55], s18 offen sc1
    buffer_load_dwordx4 v[72:75], v244, s[52:55], s19 offen sc1
    buffer_load_dwordx4 v[76:79], v245, s[52:55], s19 offen sc1
    buffer_load_dwordx4 v[80:83], v244, s[52:55], s20 offen sc1
    buffer_load_dwordx4 v[84:87], v245, s[52:55], s20 offen sc1
    buffer_load_dwordx4 v[88:91], v244, s[52:55], s21 offen sc1
    buffer_load_dwordx4 v[92:95], v245, s[52:55], s21 offen sc1
    buffer_load_dwordx4 v[96:99], v244, s[52:55], s22 offen sc1
    buffer_load_dwordx4 v[100:103], v245, s[52:55], s22 offen sc1
    ds_read_b64 v[128:129], v4 offset:0
    ds_read_b64 v[130:131], v4 offset:1024
    ds_read_b64 v[132:133], v4 offset:2048
    ds_read_b64 v[134:135], v4 offset:3072
    ds_read_b64 v[136:137], v4 offset:4096
    ds_read_b64 v[138:139], v4 offset:5120
    ds_read_b64 v[140:141], v4 offset:6144
    ds_read_b64 v[142:143], v4 offset:7168
    ds_read_b64 v[144:145], v4 offset:8192
    ds_read_b64 v[146:147], v4 offset:9216
    ds_read_b64 v[148:149], v4 offset:10240
    ds_read_b64 v[150:151], v4 offset:11264
    ds_read_b64 v[152:153], v4 offset:12288
    s_waitcnt lgkmcnt(5)
    ds_read_b64 v[154:155], v4 offset:13312
    ds_read_b64 v[156:157], v4 offset:14336
    ds_read_b64 v[158:159], v4 offset:15360
    s_waitcnt vmcnt(18)
    v_lshlrev_b32_e64 v208, 16, v48
    v_and_b32 v209, 0xffff0000, v48
    v_lshlrev_b32_e64 v64, 16, v56
    v_and_b32 v65, 0xffff0000, v56
    v_lshlrev_b32_e64 v210, 16, v49
    v_and_b32 v211, 0xffff0000, v49
    v_lshlrev_b32_e64 v66, 16, v58
    v_and_b32 v67, 0xffff0000, v58
    v_lshlrev_b32_e64 v212, 16, v50
    v_and_b32 v213, 0xffff0000, v50
    v_lshlrev_b32_e64 v68, 16, v60
    v_and_b32 v69, 0xffff0000, v60
    v_lshlrev_b32_e64 v214, 16, v51
    v_and_b32 v215, 0xffff0000, v51
    v_lshlrev_b32_e64 v70, 16, v62
    v_and_b32 v71, 0xffff0000, v62
    v_pk_add_f32 v[128:129], v[128:129], v[136:137]
    v_pk_add_f32 v[130:131], v[130:131], v[138:139]
    v_pk_add_f32 v[132:133], v[132:133], v[140:141]
    v_pk_add_f32 v[134:135], v[134:135], v[142:143]
    s_waitcnt lgkmcnt(0)
    s_nop 0
    v_pk_add_f32 v[144:145], v[144:145], v[152:153]
    v_pk_add_f32 v[146:147], v[146:147], v[154:155]
    v_pk_add_f32 v[148:149], v[148:149], v[156:157]
    v_pk_add_f32 v[150:151], v[150:151], v[158:159]
    v_pk_add_f32 v[128:129], v[128:129], v[144:145]
    v_pk_add_f32 v[130:131], v[130:131], v[146:147]
    v_pk_add_f32 v[132:133], v[132:133], v[148:149]
    v_pk_add_f32 v[134:135], v[134:135], v[150:151]
    v_fma_f32 v208, v128, v64, v208
    v_fma_f32 v209, v130, v65, v209
    v_fma_f32 v210, v132, v66, v210
    v_fma_f32 v211, v134, v67, v211
    v_fma_f32 v212, v129, v68, v212
    v_fma_f32 v213, v131, v69, v213
    v_fma_f32 v214, v133, v70, v214
    v_fma_f32 v215, v135, v71, v215
    v_cvt_pk_bf16_f32 v160, v208, v209
    v_cvt_pk_bf16_f32 v161, v210, v211
    v_cvt_pk_bf16_f32 v162, v212, v213
    v_cvt_pk_bf16_f32 v163, v214, v215
    buffer_store_dwordx4 v[160:163], v2, s[64:67], s41 offen
    s_waitcnt vmcnt(13)
    s_mov_b64 vcc, s[42:43]
    v_cndmask_b32_dpp v184, v106, v104, vcc row_ror:8 row_mask:0xf bank_mask:0xf
    v_cndmask_b32_dpp v185, v110, v108, vcc row_ror:8 row_mask:0xf bank_mask:0xf
    v_cndmask_b32_dpp v188, v107, v105, vcc row_ror:8 row_mask:0xf bank_mask:0xf
    v_cndmask_b32_dpp v189, v111, v109, vcc row_ror:8 row_mask:0xf bank_mask:0xf
    s_mov_b64 vcc, s[44:45]
    v_cndmask_b32_dpp v186, v104, v106, vcc row_ror:8 row_mask:0xf bank_mask:0xf
    v_cndmask_b32_dpp v187, v108, v110, vcc row_ror:8 row_mask:0xf bank_mask:0xf
    v_cndmask_b32_dpp v190, v105, v107, vcc row_ror:8 row_mask:0xf bank_mask:0xf
    v_cndmask_b32_dpp v191, v109, v111, vcc row_ror:8 row_mask:0xf bank_mask:0xf
    v_mfma_f32_16x16x32_bf16 v[16:19], a[0:3], v[184:187], 0
    buffer_load_dwordx4 v[104:107], v244, s[52:55], s23 offen sc1
    v_mfma_f32_16x16x32_bf16 v[20:23], a[4:7], v[184:187], 0
    buffer_load_dwordx4 v[108:111], v245, s[52:55], s23 offen sc1
    v_mfma_f32_16x16x32_bf16 v[24:27], a[8:11], v[184:187], 0
    s_waitcnt vmcnt(13)
    v_cndmask_b32_dpp v194, v112, v114, vcc row_ror:8 row_mask:0xf bank_mask:0xf
    v_mfma_f32_16x16x32_bf16 v[28:31], a[12:15], v[184:187], 0
    v_cndmask_b32_dpp v195, v116, v118, vcc row_ror:8 row_mask:0xf bank_mask:0xf
    v_cndmask_b32_dpp v198, v113, v115, vcc row_ror:8 row_mask:0xf bank_mask:0xf
    v_mfma_f32_16x16x32_bf16 v[32:35], a[0:3], v[188:191], 0
    v_cndmask_b32_dpp v199, v117, v119, vcc row_ror:8 row_mask:0xf bank_mask:0xf
    s_mov_b64 vcc, s[42:43]
    v_mfma_f32_16x16x32_bf16 v[36:39], a[4:7], v[188:191], 0
    v_cndmask_b32_dpp v192, v114, v112, vcc row_ror:8 row_mask:0xf bank_mask:0xf
    v_cndmask_b32_dpp v193, v118, v116, vcc row_ror:8 row_mask:0xf bank_mask:0xf
    v_mfma_f32_16x16x32_bf16 v[40:43], a[8:11], v[188:191], 0
    v_cndmask_b32_dpp v196, v115, v113, vcc row_ror:8 row_mask:0xf bank_mask:0xf
    v_cndmask_b32_dpp v197, v119, v117, vcc row_ror:8 row_mask:0xf bank_mask:0xf
    v_mfma_f32_16x16x32_bf16 v[44:47], a[12:15], v[188:191], 0
    v_mfma_f32_16x16x32_bf16 v[16:19], a[16:19], v[192:195], v[16:19]
    buffer_load_dwordx4 v[112:115], v244, s[52:55], s24 offen sc1
    v_mfma_f32_16x16x32_bf16 v[20:23], a[20:23], v[192:195], v[20:23]
    buffer_load_dwordx4 v[116:119], v245, s[52:55], s24 offen sc1
    v_mfma_f32_16x16x32_bf16 v[24:27], a[24:27], v[192:195], v[24:27]
    s_waitcnt vmcnt(13)
    v_cndmask_b32_dpp v184, v122, v120, vcc row_ror:8 row_mask:0xf bank_mask:0xf
    v_mfma_f32_16x16x32_bf16 v[28:31], a[28:31], v[192:195], v[28:31]
    v_cndmask_b32_dpp v185, v126, v124, vcc row_ror:8 row_mask:0xf bank_mask:0xf
    v_cndmask_b32_dpp v188, v123, v121, vcc row_ror:8 row_mask:0xf bank_mask:0xf
    v_mfma_f32_16x16x32_bf16 v[32:35], a[16:19], v[196:199], v[32:35]
    v_cndmask_b32_dpp v189, v127, v125, vcc row_ror:8 row_mask:0xf bank_mask:0xf
    s_mov_b64 vcc, s[44:45]
    v_mfma_f32_16x16x32_bf16 v[36:39], a[20:23], v[196:199], v[36:39]
    v_cndmask_b32_dpp v186, v120, v122, vcc row_ror:8 row_mask:0xf bank_mask:0xf
    v_cndmask_b32_dpp v187, v124, v126, vcc row_ror:8 row_mask:0xf bank_mask:0xf
    v_mfma_f32_16x16x32_bf16 v[40:43], a[24:27], v[196:199], v[40:43]
    v_cndmask_b32_dpp v190, v121, v123, vcc row_ror:8 row_mask:0xf bank_mask:0xf
    v_cndmask_b32_dpp v191, v125, v127, vcc row_ror:8 row_mask:0xf bank_mask:0xf
    v_mfma_f32_16x16x32_bf16 v[44:47], a[28:31], v[196:199], v[44:47]
    v_mfma_f32_16x16x32_bf16 v[16:19], a[32:35], v[184:187], v[16:19]
    buffer_load_dwordx4 v[120:123], v244, s[52:55], s25 offen sc1
    v_mfma_f32_16x16x32_bf16 v[20:23], a[36:39], v[184:187], v[20:23]
    buffer_load_dwordx4 v[124:127], v245, s[52:55], s25 offen sc1
    v_mfma_f32_16x16x32_bf16 v[24:27], a[40:43], v[184:187], v[24:27]
    s_waitcnt vmcnt(13)
    v_cndmask_b32_dpp v194, v72, v74, vcc row_ror:8 row_mask:0xf bank_mask:0xf
    v_mfma_f32_16x16x32_bf16 v[28:31], a[44:47], v[184:187], v[28:31]
    v_cndmask_b32_dpp v195, v76, v78, vcc row_ror:8 row_mask:0xf bank_mask:0xf
    v_cndmask_b32_dpp v198, v73, v75, vcc row_ror:8 row_mask:0xf bank_mask:0xf
    v_mfma_f32_16x16x32_bf16 v[32:35], a[32:35], v[188:191], v[32:35]
    v_cndmask_b32_dpp v199, v77, v79, vcc row_ror:8 row_mask:0xf bank_mask:0xf
    s_mov_b64 vcc, s[42:43]
    v_mfma_f32_16x16x32_bf16 v[36:39], a[36:39], v[188:191], v[36:39]
    v_cndmask_b32_dpp v192, v74, v72, vcc row_ror:8 row_mask:0xf bank_mask:0xf
    v_cndmask_b32_dpp v193, v78, v76, vcc row_ror:8 row_mask:0xf bank_mask:0xf
    v_mfma_f32_16x16x32_bf16 v[40:43], a[40:43], v[188:191], v[40:43]
    v_cndmask_b32_dpp v196, v75, v73, vcc row_ror:8 row_mask:0xf bank_mask:0xf
    v_cndmask_b32_dpp v197, v79, v77, vcc row_ror:8 row_mask:0xf bank_mask:0xf
    v_mfma_f32_16x16x32_bf16 v[44:47], a[44:47], v[188:191], v[44:47]
    v_mfma_f32_16x16x32_bf16 v[16:19], a[48:51], v[192:195], v[16:19]
    buffer_load_dwordx4 v[72:75], v244, s[52:55], s26 offen sc1
    v_mfma_f32_16x16x32_bf16 v[20:23], a[52:55], v[192:195], v[20:23]
    buffer_load_dwordx4 v[76:79], v245, s[52:55], s26 offen sc1
    v_mfma_f32_16x16x32_bf16 v[24:27], a[56:59], v[192:195], v[24:27]
    s_waitcnt vmcnt(13)
    v_cndmask_b32_dpp v184, v82, v80, vcc row_ror:8 row_mask:0xf bank_mask:0xf
    v_mfma_f32_16x16x32_bf16 v[28:31], a[60:63], v[192:195], v[28:31]
    v_cndmask_b32_dpp v185, v86, v84, vcc row_ror:8 row_mask:0xf bank_mask:0xf
    v_cndmask_b32_dpp v188, v83, v81, vcc row_ror:8 row_mask:0xf bank_mask:0xf
    v_mfma_f32_16x16x32_bf16 v[32:35], a[48:51], v[196:199], v[32:35]
    v_cndmask_b32_dpp v189, v87, v85, vcc row_ror:8 row_mask:0xf bank_mask:0xf
    s_mov_b64 vcc, s[44:45]
    v_mfma_f32_16x16x32_bf16 v[36:39], a[52:55], v[196:199], v[36:39]
    v_cndmask_b32_dpp v186, v80, v82, vcc row_ror:8 row_mask:0xf bank_mask:0xf
    v_cndmask_b32_dpp v187, v84, v86, vcc row_ror:8 row_mask:0xf bank_mask:0xf
    v_mfma_f32_16x16x32_bf16 v[40:43], a[56:59], v[196:199], v[40:43]
    v_cndmask_b32_dpp v190, v81, v83, vcc row_ror:8 row_mask:0xf bank_mask:0xf
    v_cndmask_b32_dpp v191, v85, v87, vcc row_ror:8 row_mask:0xf bank_mask:0xf
    v_mfma_f32_16x16x32_bf16 v[44:47], a[60:63], v[196:199], v[44:47]
    v_mfma_f32_16x16x32_bf16 v[16:19], a[64:67], v[184:187], v[16:19]
    buffer_load_dwordx4 v[80:83], v244, s[52:55], s27 offen sc1
    v_mfma_f32_16x16x32_bf16 v[20:23], a[68:71], v[184:187], v[20:23]
    buffer_load_dwordx4 v[84:87], v245, s[52:55], s27 offen sc1
    v_mfma_f32_16x16x32_bf16 v[24:27], a[72:75], v[184:187], v[24:27]
    s_waitcnt vmcnt(13)
    v_cndmask_b32_dpp v194, v88, v90, vcc row_ror:8 row_mask:0xf bank_mask:0xf
    v_mfma_f32_16x16x32_bf16 v[28:31], a[76:79], v[184:187], v[28:31]
    v_cndmask_b32_dpp v195, v92, v94, vcc row_ror:8 row_mask:0xf bank_mask:0xf
    v_cndmask_b32_dpp v198, v89, v91, vcc row_ror:8 row_mask:0xf bank_mask:0xf
    v_mfma_f32_16x16x32_bf16 v[32:35], a[64:67], v[188:191], v[32:35]
    v_cndmask_b32_dpp v199, v93, v95, vcc row_ror:8 row_mask:0xf bank_mask:0xf
    s_mov_b64 vcc, s[42:43]
    v_mfma_f32_16x16x32_bf16 v[36:39], a[68:71], v[188:191], v[36:39]
    v_cndmask_b32_dpp v192, v90, v88, vcc row_ror:8 row_mask:0xf bank_mask:0xf
    v_cndmask_b32_dpp v193, v94, v92, vcc row_ror:8 row_mask:0xf bank_mask:0xf
    v_mfma_f32_16x16x32_bf16 v[40:43], a[72:75], v[188:191], v[40:43]
    v_cndmask_b32_dpp v196, v91, v89, vcc row_ror:8 row_mask:0xf bank_mask:0xf
    v_cndmask_b32_dpp v197, v95, v93, vcc row_ror:8 row_mask:0xf bank_mask:0xf
    v_mfma_f32_16x16x32_bf16 v[44:47], a[76:79], v[188:191], v[44:47]
    v_mfma_f32_16x16x32_bf16 v[16:19], a[80:83], v[192:195], v[16:19]
    buffer_load_dwordx4 v[88:91], v244, s[52:55], s28 offen sc1
    v_mfma_f32_16x16x32_bf16 v[20:23], a[84:87], v[192:195], v[20:23]
    buffer_load_dwordx4 v[92:95], v245, s[52:55], s28 offen sc1
    v_mfma_f32_16x16x32_bf16 v[24:27], a[88:91], v[192:195], v[24:27]
    s_waitcnt vmcnt(13)
    v_cndmask_b32_dpp v184, v98, v96, vcc row_ror:8 row_mask:0xf bank_mask:0xf
    v_mfma_f32_16x16x32_bf16 v[28:31], a[92:95], v[192:195], v[28:31]
    v_cndmask_b32_dpp v185, v102, v100, vcc row_ror:8 row_mask:0xf bank_mask:0xf
    v_cndmask_b32_dpp v188, v99, v97, vcc row_ror:8 row_mask:0xf bank_mask:0xf
    v_mfma_f32_16x16x32_bf16 v[32:35], a[80:83], v[196:199], v[32:35]
    v_cndmask_b32_dpp v189, v103, v101, vcc row_ror:8 row_mask:0xf bank_mask:0xf
    s_mov_b64 vcc, s[44:45]
    v_mfma_f32_16x16x32_bf16 v[36:39], a[84:87], v[196:199], v[36:39]
    v_cndmask_b32_dpp v186, v96, v98, vcc row_ror:8 row_mask:0xf bank_mask:0xf
    v_cndmask_b32_dpp v187, v100, v102, vcc row_ror:8 row_mask:0xf bank_mask:0xf
    v_mfma_f32_16x16x32_bf16 v[40:43], a[88:91], v[196:199], v[40:43]
    v_cndmask_b32_dpp v190, v97, v99, vcc row_ror:8 row_mask:0xf bank_mask:0xf
    v_cndmask_b32_dpp v191, v101, v103, vcc row_ror:8 row_mask:0xf bank_mask:0xf
    v_mfma_f32_16x16x32_bf16 v[44:47], a[92:95], v[196:199], v[44:47]
    v_mfma_f32_16x16x32_bf16 v[16:19], a[96:99], v[184:187], v[16:19]
    buffer_load_dwordx4 v[96:99], v244, s[52:55], s29 offen sc1
    v_mfma_f32_16x16x32_bf16 v[20:23], a[100:103], v[184:187], v[20:23]
    buffer_load_dwordx4 v[100:103], v245, s[52:55], s29 offen sc1
    v_mfma_f32_16x16x32_bf16 v[24:27], a[104:107], v[184:187], v[24:27]
    s_waitcnt vmcnt(12)
    v_cndmask_b32_dpp v194, v104, v106, vcc row_ror:8 row_mask:0xf bank_mask:0xf
    v_mfma_f32_16x16x32_bf16 v[28:31], a[108:111], v[184:187], v[28:31]
    v_cndmask_b32_dpp v195, v108, v110, vcc row_ror:8 row_mask:0xf bank_mask:0xf
    v_cndmask_b32_dpp v198, v105, v107, vcc row_ror:8 row_mask:0xf bank_mask:0xf
    v_mfma_f32_16x16x32_bf16 v[32:35], a[96:99], v[188:191], v[32:35]
    v_cndmask_b32_dpp v199, v109, v111, vcc row_ror:8 row_mask:0xf bank_mask:0xf
    s_mov_b64 vcc, s[42:43]
    v_mfma_f32_16x16x32_bf16 v[36:39], a[100:103], v[188:191], v[36:39]
    v_cndmask_b32_dpp v192, v106, v104, vcc row_ror:8 row_mask:0xf bank_mask:0xf
    v_cndmask_b32_dpp v193, v110, v108, vcc row_ror:8 row_mask:0xf bank_mask:0xf
    v_mfma_f32_16x16x32_bf16 v[40:43], a[104:107], v[188:191], v[40:43]
    v_cndmask_b32_dpp v196, v107, v105, vcc row_ror:8 row_mask:0xf bank_mask:0xf
    v_cndmask_b32_dpp v197, v111, v109, vcc row_ror:8 row_mask:0xf bank_mask:0xf
    v_mfma_f32_16x16x32_bf16 v[44:47], a[108:111], v[188:191], v[44:47]
    v_mfma_f32_16x16x32_bf16 v[16:19], a[112:115], v[192:195], v[16:19]
    v_mfma_f32_16x16x32_bf16 v[20:23], a[116:119], v[192:195], v[20:23]
    v_mfma_f32_16x16x32_bf16 v[24:27], a[120:123], v[192:195], v[24:27]
    s_waitcnt vmcnt(10)
    v_cndmask_b32_dpp v184, v114, v112, vcc row_ror:8 row_mask:0xf bank_mask:0xf
    v_mfma_f32_16x16x32_bf16 v[28:31], a[124:127], v[192:195], v[28:31]
    v_cndmask_b32_dpp v185, v118, v116, vcc row_ror:8 row_mask:0xf bank_mask:0xf
    v_cndmask_b32_dpp v188, v115, v113, vcc row_ror:8 row_mask:0xf bank_mask:0xf
    v_mfma_f32_16x16x32_bf16 v[32:35], a[112:115], v[196:199], v[32:35]
    v_cndmask_b32_dpp v189, v119, v117, vcc row_ror:8 row_mask:0xf bank_mask:0xf
    s_mov_b64 vcc, s[44:45]
    v_mfma_f32_16x16x32_bf16 v[36:39], a[116:119], v[196:199], v[36:39]
    v_cndmask_b32_dpp v186, v112, v114, vcc row_ror:8 row_mask:0xf bank_mask:0xf
    v_cndmask_b32_dpp v187, v116, v118, vcc row_ror:8 row_mask:0xf bank_mask:0xf
    v_mfma_f32_16x16x32_bf16 v[40:43], a[120:123], v[196:199], v[40:43]
    v_cndmask_b32_dpp v190, v113, v115, vcc row_ror:8 row_mask:0xf bank_mask:0xf
    v_cndmask_b32_dpp v191, v117, v119, vcc row_ror:8 row_mask:0xf bank_mask:0xf
    v_mfma_f32_16x16x32_bf16 v[44:47], a[124:127], v[196:199], v[44:47]
    v_mfma_f32_16x16x32_bf16 v[16:19], a[128:131], v[184:187], v[16:19]
    v_mfma_f32_16x16x32_bf16 v[20:23], a[132:135], v[184:187], v[20:23]
    v_mfma_f32_16x16x32_bf16 v[24:27], a[136:139], v[184:187], v[24:27]
    s_waitcnt vmcnt(8)
    v_cndmask_b32_dpp v194, v120, v122, vcc row_ror:8 row_mask:0xf bank_mask:0xf
    v_mfma_f32_16x16x32_bf16 v[28:31], a[140:143], v[184:187], v[28:31]
    v_cndmask_b32_dpp v195, v124, v126, vcc row_ror:8 row_mask:0xf bank_mask:0xf
    v_cndmask_b32_dpp v198, v121, v123, vcc row_ror:8 row_mask:0xf bank_mask:0xf
    v_mfma_f32_16x16x32_bf16 v[32:35], a[128:131], v[188:191], v[32:35]
    v_cndmask_b32_dpp v199, v125, v127, vcc row_ror:8 row_mask:0xf bank_mask:0xf
    s_mov_b64 vcc, s[42:43]
    v_mfma_f32_16x16x32_bf16 v[36:39], a[132:135], v[188:191], v[36:39]
    v_cndmask_b32_dpp v192, v122, v120, vcc row_ror:8 row_mask:0xf bank_mask:0xf
    v_cndmask_b32_dpp v193, v126, v124, vcc row_ror:8 row_mask:0xf bank_mask:0xf
    v_mfma_f32_16x16x32_bf16 v[40:43], a[136:139], v[188:191], v[40:43]
    v_cndmask_b32_dpp v196, v123, v121, vcc row_ror:8 row_mask:0xf bank_mask:0xf
    v_cndmask_b32_dpp v197, v127, v125, vcc row_ror:8 row_mask:0xf bank_mask:0xf
    v_mfma_f32_16x16x32_bf16 v[44:47], a[140:143], v[188:191], v[44:47]
    v_mfma_f32_16x16x32_bf16 v[16:19], a[144:147], v[192:195], v[16:19]
    v_mfma_f32_16x16x32_bf16 v[20:23], a[148:151], v[192:195], v[20:23]
    v_mfma_f32_16x16x32_bf16 v[24:27], a[152:155], v[192:195], v[24:27]
    s_waitcnt vmcnt(6)
    v_cndmask_b32_dpp v184, v74, v72, vcc row_ror:8 row_mask:0xf bank_mask:0xf
    v_mfma_f32_16x16x32_bf16 v[28:31], a[156:159], v[192:195], v[28:31]
    v_cndmask_b32_dpp v185, v78, v76, vcc row_ror:8 row_mask:0xf bank_mask:0xf
    v_cndmask_b32_dpp v188, v75, v73, vcc row_ror:8 row_mask:0xf bank_mask:0xf
    v_mfma_f32_16x16x32_bf16 v[32:35], a[144:147], v[196:199], v[32:35]
    v_cndmask_b32_dpp v189, v79, v77, vcc row_ror:8 row_mask:0xf bank_mask:0xf
    s_mov_b64 vcc, s[44:45]
    v_mfma_f32_16x16x32_bf16 v[36:39], a[148:151], v[196:199], v[36:39]
    v_cndmask_b32_dpp v186, v72, v74, vcc row_ror:8 row_mask:0xf bank_mask:0xf
    v_cndmask_b32_dpp v187, v76, v78, vcc row_ror:8 row_mask:0xf bank_mask:0xf
    v_mfma_f32_16x16x32_bf16 v[40:43], a[152:155], v[196:199], v[40:43]
    v_cndmask_b32_dpp v190, v73, v75, vcc row_ror:8 row_mask:0xf bank_mask:0xf
    v_cndmask_b32_dpp v191, v77, v79, vcc row_ror:8 row_mask:0xf bank_mask:0xf
    v_mfma_f32_16x16x32_bf16 v[44:47], a[156:159], v[196:199], v[44:47]
    v_mfma_f32_16x16x32_bf16 v[16:19], a[160:163], v[184:187], v[16:19]
    v_mfma_f32_16x16x32_bf16 v[20:23], a[164:167], v[184:187], v[20:23]
    v_mfma_f32_16x16x32_bf16 v[24:27], a[168:171], v[184:187], v[24:27]
    s_waitcnt vmcnt(4)
    v_cndmask_b32_dpp v194, v80, v82, vcc row_ror:8 row_mask:0xf bank_mask:0xf
    v_mfma_f32_16x16x32_bf16 v[28:31], a[172:175], v[184:187], v[28:31]
    v_cndmask_b32_dpp v195, v84, v86, vcc row_ror:8 row_mask:0xf bank_mask:0xf
    v_cndmask_b32_dpp v198, v81, v83, vcc row_ror:8 row_mask:0xf bank_mask:0xf
    v_mfma_f32_16x16x32_bf16 v[32:35], a[160:163], v[188:191], v[32:35]
    v_cndmask_b32_dpp v199, v85, v87, vcc row_ror:8 row_mask:0xf bank_mask:0xf
    s_mov_b64 vcc, s[42:43]
    v_mfma_f32_16x16x32_bf16 v[36:39], a[164:167], v[188:191], v[36:39]
    v_cndmask_b32_dpp v192, v82, v80, vcc row_ror:8 row_mask:0xf bank_mask:0xf
    v_cndmask_b32_dpp v193, v86, v84, vcc row_ror:8 row_mask:0xf bank_mask:0xf
    v_mfma_f32_16x16x32_bf16 v[40:43], a[168:171], v[188:191], v[40:43]
    v_cndmask_b32_dpp v196, v83, v81, vcc row_ror:8 row_mask:0xf bank_mask:0xf
    v_cndmask_b32_dpp v197, v87, v85, vcc row_ror:8 row_mask:0xf bank_mask:0xf
    v_mfma_f32_16x16x32_bf16 v[44:47], a[172:175], v[188:191], v[44:47]
    v_mfma_f32_16x16x32_bf16 v[16:19], a[176:179], v[192:195], v[16:19]
    v_mfma_f32_16x16x32_bf16 v[20:23], a[180:183], v[192:195], v[20:23]
    v_mfma_f32_16x16x32_bf16 v[24:27], a[184:187], v[192:195], v[24:27]
    s_waitcnt vmcnt(2)
    v_cndmask_b32_dpp v184, v90, v88, vcc row_ror:8 row_mask:0xf bank_mask:0xf
    v_mfma_f32_16x16x32_bf16 v[28:31], a[188:191], v[192:195], v[28:31]
    v_cndmask_b32_dpp v185, v94, v92, vcc row_ror:8 row_mask:0xf bank_mask:0xf
    v_cndmask_b32_dpp v188, v91, v89, vcc row_ror:8 row_mask:0xf bank_mask:0xf
    v_mfma_f32_16x16x32_bf16 v[32:35], a[176:179], v[196:199], v[32:35]
    v_cndmask_b32_dpp v189, v95, v93, vcc row_ror:8 row_mask:0xf bank_mask:0xf
    s_mov_b64 vcc, s[44:45]
    v_mfma_f32_16x16x32_bf16 v[36:39], a[180:183], v[196:199], v[36:39]
    v_cndmask_b32_dpp v186, v88, v90, vcc row_ror:8 row_mask:0xf bank_mask:0xf
    v_cndmask_b32_dpp v187, v92, v94, vcc row_ror:8 row_mask:0xf bank_mask:0xf
    v_mfma_f32_16x16x32_bf16 v[40:43], a[184:187], v[196:199], v[40:43]
    v_cndmask_b32_dpp v190, v89, v91, vcc row_ror:8 row_mask:0xf bank_mask:0xf
    v_cndmask_b32_dpp v191, v93, v95, vcc row_ror:8 row_mask:0xf bank_mask:0xf
    v_mfma_f32_16x16x32_bf16 v[44:47], a[188:191], v[196:199], v[44:47]
    v_mfma_f32_16x16x32_bf16 v[16:19], a[192:195], v[184:187], v[16:19]
    v_mfma_f32_16x16x32_bf16 v[20:23], a[196:199], v[184:187], v[20:23]
    v_mfma_f32_16x16x32_bf16 v[24:27], a[200:203], v[184:187], v[24:27]
    s_waitcnt vmcnt(0)
    v_cndmask_b32_dpp v194, v96, v98, vcc row_ror:8 row_mask:0xf bank_mask:0xf
    v_mfma_f32_16x16x32_bf16 v[28:31], a[204:207], v[184:187], v[28:31]
    v_cndmask_b32_dpp v195, v100, v102, vcc row_ror:8 row_mask:0xf bank_mask:0xf
    v_cndmask_b32_dpp v198, v97, v99, vcc row_ror:8 row_mask:0xf bank_mask:0xf
    v_mfma_f32_16x16x32_bf16 v[32:35], a[192:195], v[188:191], v[32:35]
    v_cndmask_b32_dpp v199, v101, v103, vcc row_ror:8 row_mask:0xf bank_mask:0xf
    s_mov_b64 vcc, s[42:43]
    v_mfma_f32_16x16x32_bf16 v[36:39], a[196:199], v[188:191], v[36:39]
    v_cndmask_b32_dpp v192, v98, v96, vcc row_ror:8 row_mask:0xf bank_mask:0xf
    v_cndmask_b32_dpp v193, v102, v100, vcc row_ror:8 row_mask:0xf bank_mask:0xf
    v_mfma_f32_16x16x32_bf16 v[40:43], a[200:203], v[188:191], v[40:43]
    v_cndmask_b32_dpp v196, v99, v97, vcc row_ror:8 row_mask:0xf bank_mask:0xf
    v_cndmask_b32_dpp v197, v103, v101, vcc row_ror:8 row_mask:0xf bank_mask:0xf
    v_mfma_f32_16x16x32_bf16 v[44:47], a[204:207], v[188:191], v[44:47]
    v_mfma_f32_16x16x32_bf16 v[16:19], a[208:211], v[192:195], v[16:19]
    v_mfma_f32_16x16x32_bf16 v[20:23], a[212:215], v[192:195], v[20:23]
    v_mfma_f32_16x16x32_bf16 v[24:27], a[216:219], v[192:195], v[24:27]
    v_mfma_f32_16x16x32_bf16 v[28:31], a[220:223], v[192:195], v[28:31]
    v_mfma_f32_16x16x32_bf16 v[32:35], a[208:211], v[196:199], v[32:35]
    v_mfma_f32_16x16x32_bf16 v[36:39], a[212:215], v[196:199], v[36:39]
    v_mfma_f32_16x16x32_bf16 v[40:43], a[216:219], v[196:199], v[40:43]
    v_mfma_f32_16x16x32_bf16 v[44:47], a[220:223], v[196:199], v[44:47]
    s_nop 0
    v_add_u32 v3, 40960, v3
    ds_write_b128 v3, v[16:19] offset:0
    ds_write_b128 v3, v[20:23] offset:1024
    ds_write_b128 v3, v[24:27] offset:2048
    ds_write_b128 v3, v[28:31] offset:3072
    ds_write_b128 v3, v[32:35] offset:16384
    ds_write_b128 v3, v[36:39] offset:17408
    ds_write_b128 v3, v[40:43] offset:18432
    ds_write_b128 v3, v[44:47] offset:19456
    s_waitcnt lgkmcnt(0)
    s_barrier
    v_add_u32 v4, 40960, v4
    ds_read_b64 v[128:129], v4 offset:0
    ds_read_b64 v[130:131], v4 offset:1024
    ds_read_b64 v[132:133], v4 offset:2048
    ds_read_b64 v[134:135], v4 offset:3072
    ds_read_b64 v[136:137], v4 offset:4096
    ds_read_b64 v[138:139], v4 offset:5120
    ds_read_b64 v[140:141], v4 offset:6144
    ds_read_b64 v[142:143], v4 offset:7168
    ds_read_b64 v[144:145], v4 offset:8192
    ds_read_b64 v[146:147], v4 offset:9216
    ds_read_b64 v[148:149], v4 offset:10240
    ds_read_b64 v[150:151], v4 offset:11264
    ds_read_b64 v[152:153], v4 offset:12288
    s_waitcnt lgkmcnt(5)
    ds_read_b64 v[154:155], v4 offset:13312
    ds_read_b64 v[156:157], v4 offset:14336
    ds_read_b64 v[158:159], v4 offset:15360
    v_lshlrev_b32 v208, 16, v52
    v_and_b32 v209, 0xffff0000, v52
    v_lshlrev_b32_e64 v210, 16, v53
    v_and_b32 v211, 0xffff0000, v53
    v_lshlrev_b32_e64 v212, 16, v54
    v_and_b32 v213, 0xffff0000, v54
    v_lshlrev_b32_e64 v214, 16, v55
    v_and_b32 v215, 0xffff0000, v55
    v_pk_add_f32 v[128:129], v[128:129], v[136:137]
    v_pk_add_f32 v[130:131], v[130:131], v[138:139]
    v_pk_add_f32 v[132:133], v[132:133], v[140:141]
    v_pk_add_f32 v[134:135], v[134:135], v[142:143]
    s_waitcnt lgkmcnt(0)
    s_nop 0
    v_pk_add_f32 v[144:145], v[144:145], v[152:153]
    v_pk_add_f32 v[146:147], v[146:147], v[154:155]
    v_pk_add_f32 v[148:149], v[148:149], v[156:157]
    v_pk_add_f32 v[150:151], v[150:151], v[158:159]
    v_pk_add_f32 v[128:129], v[128:129], v[144:145]
    v_pk_add_f32 v[130:131], v[130:131], v[146:147]
    v_pk_add_f32 v[132:133], v[132:133], v[148:149]
    v_pk_add_f32 v[134:135], v[134:135], v[150:151]
    v_fma_f32 v208, v128, v64, v208
    v_fma_f32 v209, v130, v65, v209
    v_fma_f32 v210, v132, v66, v210
    v_fma_f32 v211, v134, v67, v211
    v_fma_f32 v212, v129, v68, v212
    v_fma_f32 v213, v131, v69, v213
    v_fma_f32 v214, v133, v70, v214
    v_fma_f32 v215, v135, v71, v215
    v_cvt_pk_bf16_f32 v160, v208, v209
    v_cvt_pk_bf16_f32 v161, v210, v211
    v_cvt_pk_bf16_f32 v162, v212, v213
    v_cvt_pk_bf16_f32 v163, v214, v215
    s_add_u32 s41, s41, 0x100000
    buffer_store_dwordx4 v[160:163], v2, s[64:67], s41 offen
L_end:
    s_endpgm
L_code_end:
.section .rodata,"a"
.p2align 6
.amdhsa_kernel adaLN_cond__ssm_conv_s4__glu_gated_glu__prompt_kernel
  .amdhsa_next_free_vgpr 512
  .amdhsa_next_free_sgpr 102
  .amdhsa_accum_offset 256
  .amdhsa_group_segment_fixed_size 0
  .amdhsa_kernarg_size 144
  .amdhsa_user_sgpr_count 2
  .amdhsa_user_sgpr_kernarg_segment_ptr 1
  .amdhsa_system_sgpr_workgroup_id_x 1
.end_amdhsa_kernel
```
